```python
import torch

def _softmax(x, axis=-1):
    return torch.softmax(x, dim=axis)
def _gelu(x):
    return torch.nn.functional.gelu(x, approximate="tanh")
def _silu(x):
    return torch.nn.functional.silu(x)
def _sigmoid(x):
    return torch.sigmoid(x)
def _layernorm(x, axis=-1, eps=1e-5):
    m = x.mean(dim=axis, keepdim=True)
    v = x.var(dim=axis, keepdim=True, unbiased=False)
    return (x - m) / torch.sqrt(v + eps)
def _scatter_add(tgt, idx, src, axis=0):
    return tgt.clone().index_add_(axis, idx, src)
def _segment_sum(src, seg, n):
    out = torch.zeros((n,) + src.shape[1:], dtype=src.dtype)
    return out.index_add_(0, seg, src)
def _pad(x, pw):
    flat = tuple(v for pair in reversed(pw) for v in pair)
    return torch.nn.functional.pad(x, flat)

kernel_name = 'standalone__gqa_block_cached__near_ridge'

def setup_inputs():

    _w = (lambda a: (lambda t: t.to(torch.bfloat16) if t.is_floating_point() else t)(torch.as_tensor(a)))
    B, Sq, D = 32, 32, 512
    Hq, Hkv, Sk, Dh = 32, 8, 512, 128
    assert Hq % Hkv == 0, (Hq, Hkv)
    return {
        "x": _w((lambda *s: torch.randn(*s, dtype=torch.bfloat16) * 0.8)(B, Sq, D)),
        "k_cache": _w((lambda *s: torch.randn(*s, dtype=torch.bfloat16) * 0.8)(B, Hkv, Sk, Dh)),
        "v_cache": _w((lambda *s: torch.randn(*s, dtype=torch.bfloat16) * 0.05)(B, Hkv, Sk, Dh)),
        "wq": _w((lambda *s: torch.randn(*s, dtype=torch.bfloat16) * 0.8)(D, Hq * Dh) * (D ** -0.5)),
        "wo": _w((lambda *s: torch.randn(*s, dtype=torch.bfloat16) * 0.05)(Hq * Dh, D) * ((Hq * Dh) ** -0.5)),
    }

def reference(x, k_cache, v_cache, wq, wo):
    B, Sq, D = x.shape
    Hq, Dh = 32, 128
    Hkv = k_cache.shape[1]
    rep = Hq // Hkv
    q = (lambda x, *d: x.permute(*d))((x @ wq).reshape(B, Sq, Hq, Dh), 0, 2, 1, 3)
    k = (lambda x, n, axis: torch.repeat_interleave(x, n, dim=axis))(k_cache, rep, axis=1)
    v = (lambda x, n, axis: torch.repeat_interleave(x, n, dim=axis))(v_cache, rep, axis=1)
    scores = torch.einsum("bhqd,bhkd->bhqk", q, k) * (Dh ** -0.5)
    p = _softmax(scores, axis=-1)
    o = torch.einsum("bhqk,bhkd->bhqd", p, v)
    return (lambda x, *d: x.permute(*d))(o, 0, 2, 1, 3).reshape(B, Sq, Hq * Dh) @ wo
```

```asm
; @launch kernel=standalone__gqa_block_cached__near_ridge_kernel grid=(256,1,1) block=(384,1,1) lds=163840
; @launch kernel=reduce_kernel grid=(256,1,1) block=(256,1,1) lds=24576
.amdgcn_target "amdgcn-amd-amdhsa--gfx950"
.text
.globl standalone__gqa_block_cached__near_ridge_kernel
.p2align 8
.type standalone__gqa_block_cached__near_ridge_kernel,@function
standalone__gqa_block_cached__near_ridge_kernel:
    s_cmp_ge_u32 s2, 256
    s_cbranch_scc1 L_k1_end
    s_load_dwordx16 s[16:31], s[0:1], 0
    v_and_b32 v1, 63, v0
    v_lshrrev_b32 v2, 6, v0
    s_nop 0
    v_readfirstlane_b32 s3, v2
    s_and_b32 s4, s2, 7
    s_lshr_b32 s5, s2, 3
    s_mov_b32 s56, 0x05040100
    s_mov_b32 s57, 0x07060302
    s_mov_b32 s58, 0x3e0293ee
    s_mov_b32 s59, 0x41000000
    s_mov_b32 s69, 0x3f803f80
    s_mov_b64 s[74:75], 0
    s_waitcnt lgkmcnt(0)
    s_mov_b32 s32, s16
    s_and_b32 s33, s17, 0xffff
    s_mov_b32 s34, 0x100000
    s_mov_b32 s35, 0x00020000
    s_mov_b32 s36, s18
    s_and_b32 s37, s19, 0xffff
    s_mov_b32 s38, 0x2000000
    s_mov_b32 s39, 0x00020000
    s_mov_b32 s40, s20
    s_and_b32 s41, s21, 0xffff
    s_mov_b32 s42, 0x2000000
    s_mov_b32 s43, 0x00020000
    s_mov_b32 s44, s22
    s_and_b32 s45, s23, 0xffff
    s_mov_b32 s46, 0x400000
    s_mov_b32 s47, 0x00020000
    s_mov_b32 s48, s24
    s_and_b32 s49, s25, 0xffff
    s_mov_b32 s50, 0x400000
    s_mov_b32 s51, 0x00020000
    s_mov_b32 s52, s30
    s_and_b32 s53, s31, 0xffff
    s_mov_b32 s54, 0x800000
    s_mov_b32 s55, 0x00020000
    s_nop 4
    s_cmp_eq_u32 s3, 4
    s_cbranch_scc1 L_kprod
    s_cmp_eq_u32 s3, 5
    s_cbranch_scc1 L_vprod
    v_and_b32 v16, 31, v1
    v_lshrrev_b32 v17, 5, v1
    s_lshl_b32 s76, s4, 2
    s_add_u32 s76, s76, s3
    s_lshl_b32 s76, s76, 8
    v_lshrrev_b32 v19, 4, v1
    v_lshlrev_b32 v2, 16, v19
    v_and_b32 v18, 15, v1
    v_lshlrev_b32 v18, 4, v18
    v_add_u32 v2, v2, v18
    v_add_u32 v2, s76, v2
    s_lshr_b32 s78, s5, 1
    s_lshl_b32 s76, s78, 18
    s_add_u32 s60, s76, 0
    s_add_u32 s61, s76, 8192
    s_add_u32 s62, s76, 16384
    s_add_u32 s63, s76, 24576
    s_add_u32 s64, s76, 32768
    s_add_u32 s65, s76, 40960
    s_add_u32 s66, s76, 49152
    s_add_u32 s67, s76, 57344
    s_lshl_b32 s79, s78, 15
    s_lshl_b32 s78, s78, 11
    s_lshl_b32 s76, s3, 8
    v_lshlrev_b32 v3, 14, v17
    v_and_b32 v20, 1, v19
    v_lshlrev_b32 v20, 12, v20
    v_add_u32 v3, v3, v20
    v_add_u32 v3, v3, v18
    v_add_u32 v3, s76, v3
    v_add_u32 v4, 0x2000, v3
    s_lshl_b32 s68, s4, 19
    s_mov_b32 s77, s68
    s_or_b32 s68, s79, s77
    v_lshlrev_b32 v13, 4, v1
    v_add_u32 v5, 0x20000, v13
    s_lshl_b32 s76, s3, 13
    s_add_u32 s76, s76, 0x4000
    v_lshrrev_b32 v20, 4, v16
    v_lshlrev_b32 v20, 10, v20
    v_lshlrev_b32 v21, 8, v17
    v_add_u32 v20, v20, v21
    v_add_u32 v20, v20, v18
    v_add_u32 v14, s76, v20
    s_lshl_b32 s76, s2, 2
    s_add_u32 s76, s76, s3
    s_lshl_b32 s76, s76, 13
    s_add_u32 s70, s76, 0
    s_add_u32 s71, s76, 4096
    buffer_load_dwordx4 v[128:131], v2, s[44:47], s60 offen
    s_add_u32 s60, s60, 0x40000
    s_and_b32 s60, s60, 0x3fffff
    buffer_load_dwordx4 v[132:135], v2, s[44:47], s61 offen
    s_add_u32 s61, s61, 0x40000
    s_and_b32 s61, s61, 0x3fffff
    buffer_load_dwordx4 v[136:139], v2, s[44:47], s62 offen
    s_add_u32 s62, s62, 0x40000
    s_and_b32 s62, s62, 0x3fffff
    buffer_load_dwordx4 v[140:143], v2, s[44:47], s63 offen
    s_add_u32 s63, s63, 0x40000
    s_and_b32 s63, s63, 0x3fffff
    buffer_load_dwordx4 v[144:147], v2, s[44:47], s64 offen
    s_add_u32 s64, s64, 0x40000
    s_and_b32 s64, s64, 0x3fffff
    buffer_load_dwordx4 v[148:151], v2, s[44:47], s65 offen
    s_add_u32 s65, s65, 0x40000
    s_and_b32 s65, s65, 0x3fffff
    buffer_load_dwordx4 v[152:155], v2, s[44:47], s66 offen
    s_add_u32 s66, s66, 0x40000
    s_and_b32 s66, s66, 0x3fffff
    buffer_load_dwordx4 v[156:159], v2, s[44:47], s67 offen
    s_add_u32 s67, s67, 0x40000
    s_and_b32 s67, s67, 0x3fffff
    buffer_load_dwordx4 v[160:163], v2, s[44:47], s60 offen
    s_add_u32 s60, s60, 0x40000
    s_and_b32 s60, s60, 0x3fffff
    buffer_load_dwordx4 v[164:167], v2, s[44:47], s61 offen
    s_add_u32 s61, s61, 0x40000
    s_and_b32 s61, s61, 0x3fffff
    buffer_load_dwordx4 v[168:171], v2, s[44:47], s62 offen
    s_add_u32 s62, s62, 0x40000
    s_and_b32 s62, s62, 0x3fffff
    buffer_load_dwordx4 v[172:175], v2, s[44:47], s63 offen
    s_add_u32 s63, s63, 0x40000
    s_and_b32 s63, s63, 0x3fffff
    buffer_load_dwordx4 v[176:179], v2, s[44:47], s64 offen
    s_add_u32 s64, s64, 0x40000
    s_and_b32 s64, s64, 0x3fffff
    buffer_load_dwordx4 v[180:183], v2, s[44:47], s65 offen
    s_add_u32 s65, s65, 0x40000
    s_and_b32 s65, s65, 0x3fffff
    buffer_load_dwordx4 v[184:187], v2, s[44:47], s66 offen
    s_add_u32 s66, s66, 0x40000
    s_and_b32 s66, s66, 0x3fffff
    buffer_load_dwordx4 v[188:191], v2, s[44:47], s67 offen
    s_add_u32 s67, s67, 0x40000
    s_and_b32 s67, s67, 0x3fffff
    buffer_load_dwordx4 v[192:195], v2, s[44:47], s60 offen
    s_add_u32 s60, s60, 0x40000
    s_and_b32 s60, s60, 0x3fffff
    buffer_load_dwordx4 v[196:199], v2, s[44:47], s61 offen
    s_add_u32 s61, s61, 0x40000
    s_and_b32 s61, s61, 0x3fffff
    buffer_load_dwordx4 v[200:203], v2, s[44:47], s62 offen
    s_add_u32 s62, s62, 0x40000
    s_and_b32 s62, s62, 0x3fffff
    buffer_load_dwordx4 v[204:207], v2, s[44:47], s63 offen
    s_add_u32 s63, s63, 0x40000
    s_and_b32 s63, s63, 0x3fffff
    buffer_load_dwordx4 v[208:211], v2, s[44:47], s64 offen
    s_add_u32 s64, s64, 0x40000
    s_and_b32 s64, s64, 0x3fffff
    buffer_load_dwordx4 v[212:215], v2, s[44:47], s65 offen
    s_add_u32 s65, s65, 0x40000
    s_and_b32 s65, s65, 0x3fffff
    buffer_load_dwordx4 v[216:219], v2, s[44:47], s66 offen
    s_add_u32 s66, s66, 0x40000
    s_and_b32 s66, s66, 0x3fffff
    buffer_load_dwordx4 v[220:223], v2, s[44:47], s67 offen
    s_add_u32 s67, s67, 0x40000
    s_and_b32 s67, s67, 0x3fffff
    s_barrier
    v_add_u32 v10, s78, v5
    s_add_u32 s78, s78, 0x800
    s_and_b32 s78, s78, 0x7fff
    ds_read_b128 v[32:35], v10 offset:0
    ds_read_b128 v[36:39], v10 offset:1024
    v_add_u32 v15, s78, v5
    s_add_u32 s78, s78, 0x800
    s_and_b32 s78, s78, 0x7fff
    ds_read_b128 v[40:43], v15 offset:0
    ds_read_b128 v[44:47], v15 offset:1024
    s_waitcnt vmcnt(22)
    v_perm_b32 v224, v132, v128, s56
    s_waitcnt vmcnt(20)
    v_perm_b32 v225, v140, v136, s56
    s_waitcnt vmcnt(18)
    v_perm_b32 v226, v148, v144, s56
    s_waitcnt vmcnt(16)
    v_perm_b32 v227, v156, v152, s56
    v_perm_b32 v228, v132, v128, s57
    v_perm_b32 v229, v140, v136, s57
    v_perm_b32 v230, v148, v144, s57
    v_perm_b32 v231, v156, v152, s57
    v_perm_b32 v232, v133, v129, s56
    v_perm_b32 v233, v141, v137, s56
    v_perm_b32 v234, v149, v145, s56
    v_perm_b32 v235, v157, v153, s56
    v_perm_b32 v236, v133, v129, s57
    v_perm_b32 v237, v141, v137, s57
    v_perm_b32 v238, v149, v145, s57
    v_perm_b32 v239, v157, v153, s57
    v_perm_b32 v240, v134, v130, s56
    v_perm_b32 v241, v142, v138, s56
    v_perm_b32 v242, v150, v146, s56
    v_perm_b32 v243, v158, v154, s56
    v_perm_b32 v244, v134, v130, s57
    v_perm_b32 v245, v142, v138, s57
    v_perm_b32 v246, v150, v146, s57
    v_perm_b32 v247, v158, v154, s57
    v_perm_b32 v248, v135, v131, s56
    v_perm_b32 v249, v143, v139, s56
    v_perm_b32 v250, v151, v147, s56
    v_perm_b32 v251, v159, v155, s56
    v_perm_b32 v252, v135, v131, s57
    v_perm_b32 v253, v143, v139, s57
    v_perm_b32 v254, v151, v147, s57
    v_perm_b32 v255, v159, v155, s57
    s_waitcnt lgkmcnt(3)
    v_mfma_f32_16x16x32_bf16 v[64:67], v[224:227], v[32:35], 0
    s_waitcnt lgkmcnt(2)
    v_mfma_f32_16x16x32_bf16 v[68:71], v[224:227], v[36:39], 0
    s_waitcnt vmcnt(14)
    v_perm_b32 v224, v164, v160, s56
    s_waitcnt vmcnt(12)
    v_perm_b32 v225, v172, v168, s56
    s_waitcnt vmcnt(10)
    v_perm_b32 v226, v180, v176, s56
    s_waitcnt vmcnt(8)
    v_perm_b32 v227, v188, v184, s56
    buffer_load_dwordx4 v[128:131], v2, s[44:47], s60 offen
    s_add_u32 s60, s60, 0x40000
    s_and_b32 s60, s60, 0x3fffff
    v_mfma_f32_16x16x32_bf16 v[72:75], v[228:231], v[32:35], 0
    v_mfma_f32_16x16x32_bf16 v[76:79], v[228:231], v[36:39], 0
    v_perm_b32 v228, v164, v160, s57
    v_perm_b32 v229, v172, v168, s57
    v_perm_b32 v230, v180, v176, s57
    v_perm_b32 v231, v188, v184, s57
    buffer_load_dwordx4 v[132:135], v2, s[44:47], s61 offen
    s_add_u32 s61, s61, 0x40000
    s_and_b32 s61, s61, 0x3fffff
    v_mfma_f32_16x16x32_bf16 v[80:83], v[232:235], v[32:35], 0
    v_mfma_f32_16x16x32_bf16 v[84:87], v[232:235], v[36:39], 0
    v_perm_b32 v232, v165, v161, s56
    v_perm_b32 v233, v173, v169, s56
    v_perm_b32 v234, v181, v177, s56
    v_perm_b32 v235, v189, v185, s56
    buffer_load_dwordx4 v[136:139], v2, s[44:47], s62 offen
    s_add_u32 s62, s62, 0x40000
    s_and_b32 s62, s62, 0x3fffff
    v_mfma_f32_16x16x32_bf16 v[88:91], v[236:239], v[32:35], 0
    v_mfma_f32_16x16x32_bf16 v[92:95], v[236:239], v[36:39], 0
    v_perm_b32 v236, v165, v161, s57
    v_perm_b32 v237, v173, v169, s57
    v_perm_b32 v238, v181, v177, s57
    v_perm_b32 v239, v189, v185, s57
    buffer_load_dwordx4 v[140:143], v2, s[44:47], s63 offen
    s_add_u32 s63, s63, 0x40000
    s_and_b32 s63, s63, 0x3fffff
    v_mfma_f32_16x16x32_bf16 v[96:99], v[240:243], v[32:35], 0
    v_mfma_f32_16x16x32_bf16 v[100:103], v[240:243], v[36:39], 0
    v_perm_b32 v240, v166, v162, s56
    v_perm_b32 v241, v174, v170, s56
    v_perm_b32 v242, v182, v178, s56
    v_perm_b32 v243, v190, v186, s56
    buffer_load_dwordx4 v[144:147], v2, s[44:47], s64 offen
    s_add_u32 s64, s64, 0x40000
    s_and_b32 s64, s64, 0x3fffff
    v_mfma_f32_16x16x32_bf16 v[104:107], v[244:247], v[32:35], 0
    v_mfma_f32_16x16x32_bf16 v[108:111], v[244:247], v[36:39], 0
    v_perm_b32 v244, v166, v162, s57
    v_perm_b32 v245, v174, v170, s57
    v_perm_b32 v246, v182, v178, s57
    v_perm_b32 v247, v190, v186, s57
    buffer_load_dwordx4 v[148:151], v2, s[44:47], s65 offen
    s_add_u32 s65, s65, 0x40000
    s_and_b32 s65, s65, 0x3fffff
    v_mfma_f32_16x16x32_bf16 v[112:115], v[248:251], v[32:35], 0
    v_mfma_f32_16x16x32_bf16 v[116:119], v[248:251], v[36:39], 0
    v_perm_b32 v248, v167, v163, s56
    v_perm_b32 v249, v175, v171, s56
    v_perm_b32 v250, v183, v179, s56
    v_perm_b32 v251, v191, v187, s56
    buffer_load_dwordx4 v[152:155], v2, s[44:47], s66 offen
    s_add_u32 s66, s66, 0x40000
    s_and_b32 s66, s66, 0x3fffff
    v_mfma_f32_16x16x32_bf16 v[120:123], v[252:255], v[32:35], 0
    v_mfma_f32_16x16x32_bf16 v[124:127], v[252:255], v[36:39], 0
    v_add_u32 v10, s78, v5
    s_add_u32 s78, s78, 0x800
    s_and_b32 s78, s78, 0x7fff
    ds_read_b128 v[32:35], v10 offset:0
    ds_read_b128 v[36:39], v10 offset:1024
    v_perm_b32 v252, v167, v163, s57
    v_perm_b32 v253, v175, v171, s57
    v_perm_b32 v254, v183, v179, s57
    v_perm_b32 v255, v191, v187, s57
    buffer_load_dwordx4 v[156:159], v2, s[44:47], s67 offen
    s_add_u32 s67, s67, 0x40000
    s_and_b32 s67, s67, 0x3fffff
    s_waitcnt lgkmcnt(3)
    v_mfma_f32_16x16x32_bf16 v[64:67], v[224:227], v[40:43], v[64:67]
    s_waitcnt lgkmcnt(2)
    v_mfma_f32_16x16x32_bf16 v[68:71], v[224:227], v[44:47], v[68:71]
    s_waitcnt vmcnt(14)
    v_perm_b32 v224, v196, v192, s56
    s_waitcnt vmcnt(12)
    v_perm_b32 v225, v204, v200, s56
    s_waitcnt vmcnt(10)
    v_perm_b32 v226, v212, v208, s56
    s_waitcnt vmcnt(8)
    v_perm_b32 v227, v220, v216, s56
    buffer_load_dwordx4 v[160:163], v2, s[44:47], s60 offen
    s_add_u32 s60, s60, 0x40000
    s_and_b32 s60, s60, 0x3fffff
    v_mfma_f32_16x16x32_bf16 v[72:75], v[228:231], v[40:43], v[72:75]
    v_mfma_f32_16x16x32_bf16 v[76:79], v[228:231], v[44:47], v[76:79]
    v_perm_b32 v228, v196, v192, s57
    v_perm_b32 v229, v204, v200, s57
    v_perm_b32 v230, v212, v208, s57
    v_perm_b32 v231, v220, v216, s57
    buffer_load_dwordx4 v[164:167], v2, s[44:47], s61 offen
    s_add_u32 s61, s61, 0x40000
    s_and_b32 s61, s61, 0x3fffff
    v_mfma_f32_16x16x32_bf16 v[80:83], v[232:235], v[40:43], v[80:83]
    v_mfma_f32_16x16x32_bf16 v[84:87], v[232:235], v[44:47], v[84:87]
    v_perm_b32 v232, v197, v193, s56
    v_perm_b32 v233, v205, v201, s56
    v_perm_b32 v234, v213, v209, s56
    v_perm_b32 v235, v221, v217, s56
    buffer_load_dwordx4 v[168:171], v2, s[44:47], s62 offen
    s_add_u32 s62, s62, 0x40000
    s_and_b32 s62, s62, 0x3fffff
    v_mfma_f32_16x16x32_bf16 v[88:91], v[236:239], v[40:43], v[88:91]
    v_mfma_f32_16x16x32_bf16 v[92:95], v[236:239], v[44:47], v[92:95]
    v_perm_b32 v236, v197, v193, s57
    v_perm_b32 v237, v205, v201, s57
    v_perm_b32 v238, v213, v209, s57
    v_perm_b32 v239, v221, v217, s57
    buffer_load_dwordx4 v[172:175], v2, s[44:47], s63 offen
    s_add_u32 s63, s63, 0x40000
    s_and_b32 s63, s63, 0x3fffff
    v_mfma_f32_16x16x32_bf16 v[96:99], v[240:243], v[40:43], v[96:99]
    v_mfma_f32_16x16x32_bf16 v[100:103], v[240:243], v[44:47], v[100:103]
    v_perm_b32 v240, v198, v194, s56
    v_perm_b32 v241, v206, v202, s56
    v_perm_b32 v242, v214, v210, s56
    v_perm_b32 v243, v222, v218, s56
    buffer_load_dwordx4 v[176:179], v2, s[44:47], s64 offen
    s_add_u32 s64, s64, 0x40000
    s_and_b32 s64, s64, 0x3fffff
    v_mfma_f32_16x16x32_bf16 v[104:107], v[244:247], v[40:43], v[104:107]
    v_mfma_f32_16x16x32_bf16 v[108:111], v[244:247], v[44:47], v[108:111]
    v_perm_b32 v244, v198, v194, s57
    v_perm_b32 v245, v206, v202, s57
    v_perm_b32 v246, v214, v210, s57
    v_perm_b32 v247, v222, v218, s57
    buffer_load_dwordx4 v[180:183], v2, s[44:47], s65 offen
    s_add_u32 s65, s65, 0x40000
    s_and_b32 s65, s65, 0x3fffff
    v_mfma_f32_16x16x32_bf16 v[112:115], v[248:251], v[40:43], v[112:115]
    v_mfma_f32_16x16x32_bf16 v[116:119], v[248:251], v[44:47], v[116:119]
    v_perm_b32 v248, v199, v195, s56
    v_perm_b32 v249, v207, v203, s56
    v_perm_b32 v250, v215, v211, s56
    v_perm_b32 v251, v223, v219, s56
    buffer_load_dwordx4 v[184:187], v2, s[44:47], s66 offen
    s_add_u32 s66, s66, 0x40000
    s_and_b32 s66, s66, 0x3fffff
    v_mfma_f32_16x16x32_bf16 v[120:123], v[252:255], v[40:43], v[120:123]
    v_mfma_f32_16x16x32_bf16 v[124:127], v[252:255], v[44:47], v[124:127]
    v_add_u32 v15, s78, v5
    s_add_u32 s78, s78, 0x800
    s_and_b32 s78, s78, 0x7fff
    ds_read_b128 v[40:43], v15 offset:0
    ds_read_b128 v[44:47], v15 offset:1024
    v_perm_b32 v252, v199, v195, s57
    v_perm_b32 v253, v207, v203, s57
    v_perm_b32 v254, v215, v211, s57
    v_perm_b32 v255, v223, v219, s57
    buffer_load_dwordx4 v[188:191], v2, s[44:47], s67 offen
    s_add_u32 s67, s67, 0x40000
    s_and_b32 s67, s67, 0x3fffff
    s_waitcnt lgkmcnt(3)
    v_mfma_f32_16x16x32_bf16 v[64:67], v[224:227], v[32:35], v[64:67]
    s_waitcnt lgkmcnt(2)
    v_mfma_f32_16x16x32_bf16 v[68:71], v[224:227], v[36:39], v[68:71]
    s_waitcnt vmcnt(14)
    v_perm_b32 v224, v132, v128, s56
    s_waitcnt vmcnt(12)
    v_perm_b32 v225, v140, v136, s56
    s_waitcnt vmcnt(10)
    v_perm_b32 v226, v148, v144, s56
    s_waitcnt vmcnt(8)
    v_perm_b32 v227, v156, v152, s56
    buffer_load_dwordx4 v[192:195], v2, s[44:47], s60 offen
    s_add_u32 s60, s60, 0x40000
    s_and_b32 s60, s60, 0x3fffff
    v_mfma_f32_16x16x32_bf16 v[72:75], v[228:231], v[32:35], v[72:75]
    v_mfma_f32_16x16x32_bf16 v[76:79], v[228:231], v[36:39], v[76:79]
    v_perm_b32 v228, v132, v128, s57
    v_perm_b32 v229, v140, v136, s57
    v_perm_b32 v230, v148, v144, s57
    v_perm_b32 v231, v156, v152, s57
    buffer_load_dwordx4 v[196:199], v2, s[44:47], s61 offen
    s_add_u32 s61, s61, 0x40000
    s_and_b32 s61, s61, 0x3fffff
    v_mfma_f32_16x16x32_bf16 v[80:83], v[232:235], v[32:35], v[80:83]
    v_mfma_f32_16x16x32_bf16 v[84:87], v[232:235], v[36:39], v[84:87]
    v_perm_b32 v232, v133, v129, s56
    v_perm_b32 v233, v141, v137, s56
    v_perm_b32 v234, v149, v145, s56
    v_perm_b32 v235, v157, v153, s56
    buffer_load_dwordx4 v[200:203], v2, s[44:47], s62 offen
    s_add_u32 s62, s62, 0x40000
    s_and_b32 s62, s62, 0x3fffff
    v_mfma_f32_16x16x32_bf16 v[88:91], v[236:239], v[32:35], v[88:91]
    v_mfma_f32_16x16x32_bf16 v[92:95], v[236:239], v[36:39], v[92:95]
    v_perm_b32 v236, v133, v129, s57
    v_perm_b32 v237, v141, v137, s57
    v_perm_b32 v238, v149, v145, s57
    v_perm_b32 v239, v157, v153, s57
    buffer_load_dwordx4 v[204:207], v2, s[44:47], s63 offen
    s_add_u32 s63, s63, 0x40000
    s_and_b32 s63, s63, 0x3fffff
    v_mfma_f32_16x16x32_bf16 v[96:99], v[240:243], v[32:35], v[96:99]
    v_mfma_f32_16x16x32_bf16 v[100:103], v[240:243], v[36:39], v[100:103]
    v_perm_b32 v240, v134, v130, s56
    v_perm_b32 v241, v142, v138, s56
    v_perm_b32 v242, v150, v146, s56
    v_perm_b32 v243, v158, v154, s56
    buffer_load_dwordx4 v[208:211], v2, s[44:47], s64 offen
    s_add_u32 s64, s64, 0x40000
    s_and_b32 s64, s64, 0x3fffff
    v_mfma_f32_16x16x32_bf16 v[104:107], v[244:247], v[32:35], v[104:107]
    v_mfma_f32_16x16x32_bf16 v[108:111], v[244:247], v[36:39], v[108:111]
    v_perm_b32 v244, v134, v130, s57
    v_perm_b32 v245, v142, v138, s57
    v_perm_b32 v246, v150, v146, s57
    v_perm_b32 v247, v158, v154, s57
    buffer_load_dwordx4 v[212:215], v2, s[44:47], s65 offen
    s_add_u32 s65, s65, 0x40000
    s_and_b32 s65, s65, 0x3fffff
    v_mfma_f32_16x16x32_bf16 v[112:115], v[248:251], v[32:35], v[112:115]
    v_mfma_f32_16x16x32_bf16 v[116:119], v[248:251], v[36:39], v[116:119]
    v_perm_b32 v248, v135, v131, s56
    v_perm_b32 v249, v143, v139, s56
    v_perm_b32 v250, v151, v147, s56
    v_perm_b32 v251, v159, v155, s56
    buffer_load_dwordx4 v[216:219], v2, s[44:47], s66 offen
    s_add_u32 s66, s66, 0x40000
    s_and_b32 s66, s66, 0x3fffff
    v_mfma_f32_16x16x32_bf16 v[120:123], v[252:255], v[32:35], v[120:123]
    v_mfma_f32_16x16x32_bf16 v[124:127], v[252:255], v[36:39], v[124:127]
    v_add_u32 v10, s78, v5
    s_add_u32 s78, s78, 0x800
    s_and_b32 s78, s78, 0x7fff
    ds_read_b128 v[32:35], v10 offset:0
    ds_read_b128 v[36:39], v10 offset:1024
    v_perm_b32 v252, v135, v131, s57
    v_perm_b32 v253, v143, v139, s57
    v_perm_b32 v254, v151, v147, s57
    v_perm_b32 v255, v159, v155, s57
    buffer_load_dwordx4 v[220:223], v2, s[44:47], s67 offen
    s_add_u32 s67, s67, 0x40000
    s_and_b32 s67, s67, 0x3fffff
    s_waitcnt lgkmcnt(3)
    v_mfma_f32_16x16x32_bf16 v[64:67], v[224:227], v[40:43], v[64:67]
    s_waitcnt lgkmcnt(2)
    v_mfma_f32_16x16x32_bf16 v[68:71], v[224:227], v[44:47], v[68:71]
    s_waitcnt vmcnt(14)
    v_perm_b32 v224, v164, v160, s56
    s_waitcnt vmcnt(12)
    v_perm_b32 v225, v172, v168, s56
    s_waitcnt vmcnt(10)
    v_perm_b32 v226, v180, v176, s56
    s_waitcnt vmcnt(8)
    v_perm_b32 v227, v188, v184, s56
    buffer_load_dwordx4 v[128:131], v2, s[44:47], s60 offen
    s_add_u32 s60, s60, 0x40000
    s_and_b32 s60, s60, 0x3fffff
    v_mfma_f32_16x16x32_bf16 v[72:75], v[228:231], v[40:43], v[72:75]
    v_mfma_f32_16x16x32_bf16 v[76:79], v[228:231], v[44:47], v[76:79]
    v_perm_b32 v228, v164, v160, s57
    v_perm_b32 v229, v172, v168, s57
    v_perm_b32 v230, v180, v176, s57
    v_perm_b32 v231, v188, v184, s57
    buffer_load_dwordx4 v[132:135], v2, s[44:47], s61 offen
    s_add_u32 s61, s61, 0x40000
    s_and_b32 s61, s61, 0x3fffff
    v_mfma_f32_16x16x32_bf16 v[80:83], v[232:235], v[40:43], v[80:83]
    v_mfma_f32_16x16x32_bf16 v[84:87], v[232:235], v[44:47], v[84:87]
    v_perm_b32 v232, v165, v161, s56
    v_perm_b32 v233, v173, v169, s56
    v_perm_b32 v234, v181, v177, s56
    v_perm_b32 v235, v189, v185, s56
    buffer_load_dwordx4 v[136:139], v2, s[44:47], s62 offen
    s_add_u32 s62, s62, 0x40000
    s_and_b32 s62, s62, 0x3fffff
    v_mfma_f32_16x16x32_bf16 v[88:91], v[236:239], v[40:43], v[88:91]
    v_mfma_f32_16x16x32_bf16 v[92:95], v[236:239], v[44:47], v[92:95]
    v_perm_b32 v236, v165, v161, s57
    v_perm_b32 v237, v173, v169, s57
    v_perm_b32 v238, v181, v177, s57
    v_perm_b32 v239, v189, v185, s57
    buffer_load_dwordx4 v[140:143], v2, s[44:47], s63 offen
    s_add_u32 s63, s63, 0x40000
    s_and_b32 s63, s63, 0x3fffff
    v_mfma_f32_16x16x32_bf16 v[96:99], v[240:243], v[40:43], v[96:99]
    v_mfma_f32_16x16x32_bf16 v[100:103], v[240:243], v[44:47], v[100:103]
    v_perm_b32 v240, v166, v162, s56
    v_perm_b32 v241, v174, v170, s56
    v_perm_b32 v242, v182, v178, s56
    v_perm_b32 v243, v190, v186, s56
    buffer_load_dwordx4 v[144:147], v2, s[44:47], s64 offen
    s_add_u32 s64, s64, 0x40000
    s_and_b32 s64, s64, 0x3fffff
    v_mfma_f32_16x16x32_bf16 v[104:107], v[244:247], v[40:43], v[104:107]
    v_mfma_f32_16x16x32_bf16 v[108:111], v[244:247], v[44:47], v[108:111]
    v_perm_b32 v244, v166, v162, s57
    v_perm_b32 v245, v174, v170, s57
    v_perm_b32 v246, v182, v178, s57
    v_perm_b32 v247, v190, v186, s57
    buffer_load_dwordx4 v[148:151], v2, s[44:47], s65 offen
    s_add_u32 s65, s65, 0x40000
    s_and_b32 s65, s65, 0x3fffff
    v_mfma_f32_16x16x32_bf16 v[112:115], v[248:251], v[40:43], v[112:115]
    v_mfma_f32_16x16x32_bf16 v[116:119], v[248:251], v[44:47], v[116:119]
    v_perm_b32 v248, v167, v163, s56
    v_perm_b32 v249, v175, v171, s56
    v_perm_b32 v250, v183, v179, s56
    v_perm_b32 v251, v191, v187, s56
    buffer_load_dwordx4 v[152:155], v2, s[44:47], s66 offen
    s_add_u32 s66, s66, 0x40000
    s_and_b32 s66, s66, 0x3fffff
    v_mfma_f32_16x16x32_bf16 v[120:123], v[252:255], v[40:43], v[120:123]
    v_mfma_f32_16x16x32_bf16 v[124:127], v[252:255], v[44:47], v[124:127]
    v_add_u32 v15, s78, v5
    s_add_u32 s78, s78, 0x800
    s_and_b32 s78, s78, 0x7fff
    ds_read_b128 v[40:43], v15 offset:0
    ds_read_b128 v[44:47], v15 offset:1024
    v_perm_b32 v252, v167, v163, s57
    v_perm_b32 v253, v175, v171, s57
    v_perm_b32 v254, v183, v179, s57
    v_perm_b32 v255, v191, v187, s57
    buffer_load_dwordx4 v[156:159], v2, s[44:47], s67 offen
    s_add_u32 s67, s67, 0x40000
    s_and_b32 s67, s67, 0x3fffff
    s_waitcnt lgkmcnt(3)
    v_mfma_f32_16x16x32_bf16 v[64:67], v[224:227], v[32:35], v[64:67]
    s_waitcnt lgkmcnt(2)
    v_mfma_f32_16x16x32_bf16 v[68:71], v[224:227], v[36:39], v[68:71]
    s_waitcnt vmcnt(14)
    v_perm_b32 v224, v196, v192, s56
    s_waitcnt vmcnt(12)
    v_perm_b32 v225, v204, v200, s56
    s_waitcnt vmcnt(10)
    v_perm_b32 v226, v212, v208, s56
    s_waitcnt vmcnt(8)
    v_perm_b32 v227, v220, v216, s56
    buffer_load_dwordx4 v[160:163], v2, s[44:47], s60 offen
    s_add_u32 s60, s60, 0x40000
    s_and_b32 s60, s60, 0x3fffff
    v_mfma_f32_16x16x32_bf16 v[72:75], v[228:231], v[32:35], v[72:75]
    v_mfma_f32_16x16x32_bf16 v[76:79], v[228:231], v[36:39], v[76:79]
    v_perm_b32 v228, v196, v192, s57
    v_perm_b32 v229, v204, v200, s57
    v_perm_b32 v230, v212, v208, s57
    v_perm_b32 v231, v220, v216, s57
    buffer_load_dwordx4 v[164:167], v2, s[44:47], s61 offen
    s_add_u32 s61, s61, 0x40000
    s_and_b32 s61, s61, 0x3fffff
    v_mfma_f32_16x16x32_bf16 v[80:83], v[232:235], v[32:35], v[80:83]
    v_mfma_f32_16x16x32_bf16 v[84:87], v[232:235], v[36:39], v[84:87]
    v_perm_b32 v232, v197, v193, s56
    v_perm_b32 v233, v205, v201, s56
    v_perm_b32 v234, v213, v209, s56
    v_perm_b32 v235, v221, v217, s56
    buffer_load_dwordx4 v[168:171], v2, s[44:47], s62 offen
    s_add_u32 s62, s62, 0x40000
    s_and_b32 s62, s62, 0x3fffff
    v_mfma_f32_16x16x32_bf16 v[88:91], v[236:239], v[32:35], v[88:91]
    v_mfma_f32_16x16x32_bf16 v[92:95], v[236:239], v[36:39], v[92:95]
    v_perm_b32 v236, v197, v193, s57
    v_perm_b32 v237, v205, v201, s57
    v_perm_b32 v238, v213, v209, s57
    v_perm_b32 v239, v221, v217, s57
    buffer_load_dwordx4 v[172:175], v2, s[44:47], s63 offen
    s_add_u32 s63, s63, 0x40000
    s_and_b32 s63, s63, 0x3fffff
    v_mfma_f32_16x16x32_bf16 v[96:99], v[240:243], v[32:35], v[96:99]
    v_mfma_f32_16x16x32_bf16 v[100:103], v[240:243], v[36:39], v[100:103]
    v_perm_b32 v240, v198, v194, s56
    v_perm_b32 v241, v206, v202, s56
    v_perm_b32 v242, v214, v210, s56
    v_perm_b32 v243, v222, v218, s56
    buffer_load_dwordx4 v[176:179], v2, s[44:47], s64 offen
    s_add_u32 s64, s64, 0x40000
    s_and_b32 s64, s64, 0x3fffff
    v_mfma_f32_16x16x32_bf16 v[104:107], v[244:247], v[32:35], v[104:107]
    v_mfma_f32_16x16x32_bf16 v[108:111], v[244:247], v[36:39], v[108:111]
    v_perm_b32 v244, v198, v194, s57
    v_perm_b32 v245, v206, v202, s57
    v_perm_b32 v246, v214, v210, s57
    v_perm_b32 v247, v222, v218, s57
    buffer_load_dwordx4 v[180:183], v2, s[44:47], s65 offen
    s_add_u32 s65, s65, 0x40000
    s_and_b32 s65, s65, 0x3fffff
    v_mfma_f32_16x16x32_bf16 v[112:115], v[248:251], v[32:35], v[112:115]
    v_mfma_f32_16x16x32_bf16 v[116:119], v[248:251], v[36:39], v[116:119]
    v_perm_b32 v248, v199, v195, s56
    v_perm_b32 v249, v207, v203, s56
    v_perm_b32 v250, v215, v211, s56
    v_perm_b32 v251, v223, v219, s56
    buffer_load_dwordx4 v[184:187], v2, s[44:47], s66 offen
    s_add_u32 s66, s66, 0x40000
    s_and_b32 s66, s66, 0x3fffff
    v_mfma_f32_16x16x32_bf16 v[120:123], v[252:255], v[32:35], v[120:123]
    v_mfma_f32_16x16x32_bf16 v[124:127], v[252:255], v[36:39], v[124:127]
    v_add_u32 v10, s78, v5
    s_add_u32 s78, s78, 0x800
    s_and_b32 s78, s78, 0x7fff
    ds_read_b128 v[32:35], v10 offset:0
    ds_read_b128 v[36:39], v10 offset:1024
    v_perm_b32 v252, v199, v195, s57
    v_perm_b32 v253, v207, v203, s57
    v_perm_b32 v254, v215, v211, s57
    v_perm_b32 v255, v223, v219, s57
    buffer_load_dwordx4 v[188:191], v2, s[44:47], s67 offen
    s_add_u32 s67, s67, 0x40000
    s_and_b32 s67, s67, 0x3fffff
    s_waitcnt lgkmcnt(3)
    v_mfma_f32_16x16x32_bf16 v[64:67], v[224:227], v[40:43], v[64:67]
    s_waitcnt lgkmcnt(2)
    v_mfma_f32_16x16x32_bf16 v[68:71], v[224:227], v[44:47], v[68:71]
    s_waitcnt vmcnt(14)
    v_perm_b32 v224, v132, v128, s56
    s_waitcnt vmcnt(12)
    v_perm_b32 v225, v140, v136, s56
    s_waitcnt vmcnt(10)
    v_perm_b32 v226, v148, v144, s56
    s_waitcnt vmcnt(8)
    v_perm_b32 v227, v156, v152, s56
    buffer_load_dwordx4 v[192:195], v2, s[44:47], s60 offen
    s_add_u32 s60, s60, 0x40000
    s_and_b32 s60, s60, 0x3fffff
    v_mfma_f32_16x16x32_bf16 v[72:75], v[228:231], v[40:43], v[72:75]
    v_mfma_f32_16x16x32_bf16 v[76:79], v[228:231], v[44:47], v[76:79]
    v_perm_b32 v228, v132, v128, s57
    v_perm_b32 v229, v140, v136, s57
    v_perm_b32 v230, v148, v144, s57
    v_perm_b32 v231, v156, v152, s57
    buffer_load_dwordx4 v[196:199], v2, s[44:47], s61 offen
    s_add_u32 s61, s61, 0x40000
    s_and_b32 s61, s61, 0x3fffff
    v_mfma_f32_16x16x32_bf16 v[80:83], v[232:235], v[40:43], v[80:83]
    v_mfma_f32_16x16x32_bf16 v[84:87], v[232:235], v[44:47], v[84:87]
    v_perm_b32 v232, v133, v129, s56
    v_perm_b32 v233, v141, v137, s56
    v_perm_b32 v234, v149, v145, s56
    v_perm_b32 v235, v157, v153, s56
    buffer_load_dwordx4 v[200:203], v2, s[44:47], s62 offen
    s_add_u32 s62, s62, 0x40000
    s_and_b32 s62, s62, 0x3fffff
    v_mfma_f32_16x16x32_bf16 v[88:91], v[236:239], v[40:43], v[88:91]
    v_mfma_f32_16x16x32_bf16 v[92:95], v[236:239], v[44:47], v[92:95]
    v_perm_b32 v236, v133, v129, s57
    v_perm_b32 v237, v141, v137, s57
    v_perm_b32 v238, v149, v145, s57
    v_perm_b32 v239, v157, v153, s57
    buffer_load_dwordx4 v[204:207], v2, s[44:47], s63 offen
    s_add_u32 s63, s63, 0x40000
    s_and_b32 s63, s63, 0x3fffff
    v_mfma_f32_16x16x32_bf16 v[96:99], v[240:243], v[40:43], v[96:99]
    v_mfma_f32_16x16x32_bf16 v[100:103], v[240:243], v[44:47], v[100:103]
    v_perm_b32 v240, v134, v130, s56
    v_perm_b32 v241, v142, v138, s56
    v_perm_b32 v242, v150, v146, s56
    v_perm_b32 v243, v158, v154, s56
    buffer_load_dwordx4 v[208:211], v2, s[44:47], s64 offen
    s_add_u32 s64, s64, 0x40000
    s_and_b32 s64, s64, 0x3fffff
    v_mfma_f32_16x16x32_bf16 v[104:107], v[244:247], v[40:43], v[104:107]
    v_mfma_f32_16x16x32_bf16 v[108:111], v[244:247], v[44:47], v[108:111]
    v_perm_b32 v244, v134, v130, s57
    v_perm_b32 v245, v142, v138, s57
    v_perm_b32 v246, v150, v146, s57
    v_perm_b32 v247, v158, v154, s57
    buffer_load_dwordx4 v[212:215], v2, s[44:47], s65 offen
    s_add_u32 s65, s65, 0x40000
    s_and_b32 s65, s65, 0x3fffff
    v_mfma_f32_16x16x32_bf16 v[112:115], v[248:251], v[40:43], v[112:115]
    v_mfma_f32_16x16x32_bf16 v[116:119], v[248:251], v[44:47], v[116:119]
    v_perm_b32 v248, v135, v131, s56
    v_perm_b32 v249, v143, v139, s56
    v_perm_b32 v250, v151, v147, s56
    v_perm_b32 v251, v159, v155, s56
    buffer_load_dwordx4 v[216:219], v2, s[44:47], s66 offen
    s_add_u32 s66, s66, 0x40000
    s_and_b32 s66, s66, 0x3fffff
    v_mfma_f32_16x16x32_bf16 v[120:123], v[252:255], v[40:43], v[120:123]
    v_mfma_f32_16x16x32_bf16 v[124:127], v[252:255], v[44:47], v[124:127]
    v_add_u32 v15, s78, v5
    s_add_u32 s78, s78, 0x800
    s_and_b32 s78, s78, 0x7fff
    ds_read_b128 v[40:43], v15 offset:0
    ds_read_b128 v[44:47], v15 offset:1024
    v_perm_b32 v252, v135, v131, s57
    v_perm_b32 v253, v143, v139, s57
    v_perm_b32 v254, v151, v147, s57
    v_perm_b32 v255, v159, v155, s57
    buffer_load_dwordx4 v[220:223], v2, s[44:47], s67 offen
    s_add_u32 s67, s67, 0x40000
    s_and_b32 s67, s67, 0x3fffff
    s_waitcnt lgkmcnt(3)
    v_mfma_f32_16x16x32_bf16 v[64:67], v[224:227], v[32:35], v[64:67]
    s_waitcnt lgkmcnt(2)
    v_mfma_f32_16x16x32_bf16 v[68:71], v[224:227], v[36:39], v[68:71]
    s_waitcnt vmcnt(14)
    v_perm_b32 v224, v164, v160, s56
    s_waitcnt vmcnt(12)
    v_perm_b32 v225, v172, v168, s56
    s_waitcnt vmcnt(10)
    v_perm_b32 v226, v180, v176, s56
    s_waitcnt vmcnt(8)
    v_perm_b32 v227, v188, v184, s56
    buffer_load_dwordx4 v[128:131], v2, s[44:47], s60 offen
    s_add_u32 s60, s60, 0x40000
    s_and_b32 s60, s60, 0x3fffff
    v_mfma_f32_16x16x32_bf16 v[72:75], v[228:231], v[32:35], v[72:75]
    v_mfma_f32_16x16x32_bf16 v[76:79], v[228:231], v[36:39], v[76:79]
    v_perm_b32 v228, v164, v160, s57
    v_perm_b32 v229, v172, v168, s57
    v_perm_b32 v230, v180, v176, s57
    v_perm_b32 v231, v188, v184, s57
    buffer_load_dwordx4 v[132:135], v2, s[44:47], s61 offen
    s_add_u32 s61, s61, 0x40000
    s_and_b32 s61, s61, 0x3fffff
    v_mfma_f32_16x16x32_bf16 v[80:83], v[232:235], v[32:35], v[80:83]
    v_mfma_f32_16x16x32_bf16 v[84:87], v[232:235], v[36:39], v[84:87]
    v_perm_b32 v232, v165, v161, s56
    v_perm_b32 v233, v173, v169, s56
    v_perm_b32 v234, v181, v177, s56
    v_perm_b32 v235, v189, v185, s56
    buffer_load_dwordx4 v[136:139], v2, s[44:47], s62 offen
    s_add_u32 s62, s62, 0x40000
    s_and_b32 s62, s62, 0x3fffff
    v_mfma_f32_16x16x32_bf16 v[88:91], v[236:239], v[32:35], v[88:91]
    v_mfma_f32_16x16x32_bf16 v[92:95], v[236:239], v[36:39], v[92:95]
    v_perm_b32 v236, v165, v161, s57
    v_perm_b32 v237, v173, v169, s57
    v_perm_b32 v238, v181, v177, s57
    v_perm_b32 v239, v189, v185, s57
    buffer_load_dwordx4 v[140:143], v2, s[44:47], s63 offen
    s_add_u32 s63, s63, 0x40000
    s_and_b32 s63, s63, 0x3fffff
    v_mfma_f32_16x16x32_bf16 v[96:99], v[240:243], v[32:35], v[96:99]
    v_mfma_f32_16x16x32_bf16 v[100:103], v[240:243], v[36:39], v[100:103]
    v_perm_b32 v240, v166, v162, s56
    v_perm_b32 v241, v174, v170, s56
    v_perm_b32 v242, v182, v178, s56
    v_perm_b32 v243, v190, v186, s56
    buffer_load_dwordx4 v[144:147], v2, s[44:47], s64 offen
    s_add_u32 s64, s64, 0x40000
    s_and_b32 s64, s64, 0x3fffff
    v_mfma_f32_16x16x32_bf16 v[104:107], v[244:247], v[32:35], v[104:107]
    v_mfma_f32_16x16x32_bf16 v[108:111], v[244:247], v[36:39], v[108:111]
    v_perm_b32 v244, v166, v162, s57
    v_perm_b32 v245, v174, v170, s57
    v_perm_b32 v246, v182, v178, s57
    v_perm_b32 v247, v190, v186, s57
    buffer_load_dwordx4 v[148:151], v2, s[44:47], s65 offen
    s_add_u32 s65, s65, 0x40000
    s_and_b32 s65, s65, 0x3fffff
    v_mfma_f32_16x16x32_bf16 v[112:115], v[248:251], v[32:35], v[112:115]
    v_mfma_f32_16x16x32_bf16 v[116:119], v[248:251], v[36:39], v[116:119]
    v_perm_b32 v248, v167, v163, s56
    v_perm_b32 v249, v175, v171, s56
    v_perm_b32 v250, v183, v179, s56
    v_perm_b32 v251, v191, v187, s56
    buffer_load_dwordx4 v[152:155], v2, s[44:47], s66 offen
    s_add_u32 s66, s66, 0x40000
    s_and_b32 s66, s66, 0x3fffff
    v_mfma_f32_16x16x32_bf16 v[120:123], v[252:255], v[32:35], v[120:123]
    v_mfma_f32_16x16x32_bf16 v[124:127], v[252:255], v[36:39], v[124:127]
    v_add_u32 v10, s78, v5
    s_add_u32 s78, s78, 0x800
    s_and_b32 s78, s78, 0x7fff
    ds_read_b128 v[32:35], v10 offset:0
    ds_read_b128 v[36:39], v10 offset:1024
    v_perm_b32 v252, v167, v163, s57
    v_perm_b32 v253, v175, v171, s57
    v_perm_b32 v254, v183, v179, s57
    v_perm_b32 v255, v191, v187, s57
    buffer_load_dwordx4 v[156:159], v2, s[44:47], s67 offen
    s_add_u32 s67, s67, 0x40000
    s_and_b32 s67, s67, 0x3fffff
    s_waitcnt lgkmcnt(3)
    v_mfma_f32_16x16x32_bf16 v[64:67], v[224:227], v[40:43], v[64:67]
    s_waitcnt lgkmcnt(2)
    v_mfma_f32_16x16x32_bf16 v[68:71], v[224:227], v[44:47], v[68:71]
    s_waitcnt vmcnt(14)
    v_perm_b32 v224, v196, v192, s56
    s_waitcnt vmcnt(12)
    v_perm_b32 v225, v204, v200, s56
    s_waitcnt vmcnt(10)
    v_perm_b32 v226, v212, v208, s56
    s_waitcnt vmcnt(8)
    v_perm_b32 v227, v220, v216, s56
    buffer_load_dwordx4 v[160:163], v2, s[44:47], s60 offen
    s_add_u32 s60, s60, 0x40000
    s_and_b32 s60, s60, 0x3fffff
    v_mfma_f32_16x16x32_bf16 v[72:75], v[228:231], v[40:43], v[72:75]
    v_mfma_f32_16x16x32_bf16 v[76:79], v[228:231], v[44:47], v[76:79]
    v_perm_b32 v228, v196, v192, s57
    v_perm_b32 v229, v204, v200, s57
    v_perm_b32 v230, v212, v208, s57
    v_perm_b32 v231, v220, v216, s57
    buffer_load_dwordx4 v[164:167], v2, s[44:47], s61 offen
    s_add_u32 s61, s61, 0x40000
    s_and_b32 s61, s61, 0x3fffff
    v_mfma_f32_16x16x32_bf16 v[80:83], v[232:235], v[40:43], v[80:83]
    v_mfma_f32_16x16x32_bf16 v[84:87], v[232:235], v[44:47], v[84:87]
    v_perm_b32 v232, v197, v193, s56
    v_perm_b32 v233, v205, v201, s56
    v_perm_b32 v234, v213, v209, s56
    v_perm_b32 v235, v221, v217, s56
    buffer_load_dwordx4 v[168:171], v2, s[44:47], s62 offen
    s_add_u32 s62, s62, 0x40000
    s_and_b32 s62, s62, 0x3fffff
    v_mfma_f32_16x16x32_bf16 v[88:91], v[236:239], v[40:43], v[88:91]
    v_mfma_f32_16x16x32_bf16 v[92:95], v[236:239], v[44:47], v[92:95]
    v_perm_b32 v236, v197, v193, s57
    v_perm_b32 v237, v205, v201, s57
    v_perm_b32 v238, v213, v209, s57
    v_perm_b32 v239, v221, v217, s57
    buffer_load_dwordx4 v[172:175], v2, s[44:47], s63 offen
    s_add_u32 s63, s63, 0x40000
    s_and_b32 s63, s63, 0x3fffff
    v_mfma_f32_16x16x32_bf16 v[96:99], v[240:243], v[40:43], v[96:99]
    v_mfma_f32_16x16x32_bf16 v[100:103], v[240:243], v[44:47], v[100:103]
    v_perm_b32 v240, v198, v194, s56
    v_perm_b32 v241, v206, v202, s56
    v_perm_b32 v242, v214, v210, s56
    v_perm_b32 v243, v222, v218, s56
    buffer_load_dwordx4 v[176:179], v2, s[44:47], s64 offen
    s_add_u32 s64, s64, 0x40000
    s_and_b32 s64, s64, 0x3fffff
    v_mfma_f32_16x16x32_bf16 v[104:107], v[244:247], v[40:43], v[104:107]
    v_mfma_f32_16x16x32_bf16 v[108:111], v[244:247], v[44:47], v[108:111]
    v_perm_b32 v244, v198, v194, s57
    v_perm_b32 v245, v206, v202, s57
    v_perm_b32 v246, v214, v210, s57
    v_perm_b32 v247, v222, v218, s57
    buffer_load_dwordx4 v[180:183], v2, s[44:47], s65 offen
    s_add_u32 s65, s65, 0x40000
    s_and_b32 s65, s65, 0x3fffff
    v_mfma_f32_16x16x32_bf16 v[112:115], v[248:251], v[40:43], v[112:115]
    v_mfma_f32_16x16x32_bf16 v[116:119], v[248:251], v[44:47], v[116:119]
    v_perm_b32 v248, v199, v195, s56
    v_perm_b32 v249, v207, v203, s56
    v_perm_b32 v250, v215, v211, s56
    v_perm_b32 v251, v223, v219, s56
    buffer_load_dwordx4 v[184:187], v2, s[44:47], s66 offen
    s_add_u32 s66, s66, 0x40000
    s_and_b32 s66, s66, 0x3fffff
    v_mfma_f32_16x16x32_bf16 v[120:123], v[252:255], v[40:43], v[120:123]
    v_mfma_f32_16x16x32_bf16 v[124:127], v[252:255], v[44:47], v[124:127]
    v_add_u32 v15, s78, v5
    s_add_u32 s78, s78, 0x800
    s_and_b32 s78, s78, 0x7fff
    ds_read_b128 v[40:43], v15 offset:0
    ds_read_b128 v[44:47], v15 offset:1024
    v_perm_b32 v252, v199, v195, s57
    v_perm_b32 v253, v207, v203, s57
    v_perm_b32 v254, v215, v211, s57
    v_perm_b32 v255, v223, v219, s57
    buffer_load_dwordx4 v[188:191], v2, s[44:47], s67 offen
    s_add_u32 s67, s67, 0x40000
    s_and_b32 s67, s67, 0x3fffff
    s_waitcnt lgkmcnt(3)
    v_mfma_f32_16x16x32_bf16 v[64:67], v[224:227], v[32:35], v[64:67]
    s_waitcnt lgkmcnt(2)
    v_mfma_f32_16x16x32_bf16 v[68:71], v[224:227], v[36:39], v[68:71]
    s_waitcnt vmcnt(14)
    v_perm_b32 v224, v132, v128, s56
    s_waitcnt vmcnt(12)
    v_perm_b32 v225, v140, v136, s56
    s_waitcnt vmcnt(10)
    v_perm_b32 v226, v148, v144, s56
    s_waitcnt vmcnt(8)
    v_perm_b32 v227, v156, v152, s56
    buffer_load_dwordx4 v[192:195], v2, s[44:47], s60 offen
    s_add_u32 s60, s60, 0x40000
    s_and_b32 s60, s60, 0x3fffff
    v_mfma_f32_16x16x32_bf16 v[72:75], v[228:231], v[32:35], v[72:75]
    v_mfma_f32_16x16x32_bf16 v[76:79], v[228:231], v[36:39], v[76:79]
    v_perm_b32 v228, v132, v128, s57
    v_perm_b32 v229, v140, v136, s57
    v_perm_b32 v230, v148, v144, s57
    v_perm_b32 v231, v156, v152, s57
    buffer_load_dwordx4 v[196:199], v2, s[44:47], s61 offen
    s_add_u32 s61, s61, 0x40000
    s_and_b32 s61, s61, 0x3fffff
    v_mfma_f32_16x16x32_bf16 v[80:83], v[232:235], v[32:35], v[80:83]
    v_mfma_f32_16x16x32_bf16 v[84:87], v[232:235], v[36:39], v[84:87]
    v_perm_b32 v232, v133, v129, s56
    v_perm_b32 v233, v141, v137, s56
    v_perm_b32 v234, v149, v145, s56
    v_perm_b32 v235, v157, v153, s56
    buffer_load_dwordx4 v[200:203], v2, s[44:47], s62 offen
    s_add_u32 s62, s62, 0x40000
    s_and_b32 s62, s62, 0x3fffff
    v_mfma_f32_16x16x32_bf16 v[88:91], v[236:239], v[32:35], v[88:91]
    v_mfma_f32_16x16x32_bf16 v[92:95], v[236:239], v[36:39], v[92:95]
    v_perm_b32 v236, v133, v129, s57
    v_perm_b32 v237, v141, v137, s57
    v_perm_b32 v238, v149, v145, s57
    v_perm_b32 v239, v157, v153, s57
    buffer_load_dwordx4 v[204:207], v2, s[44:47], s63 offen
    s_add_u32 s63, s63, 0x40000
    s_and_b32 s63, s63, 0x3fffff
    v_mfma_f32_16x16x32_bf16 v[96:99], v[240:243], v[32:35], v[96:99]
    v_mfma_f32_16x16x32_bf16 v[100:103], v[240:243], v[36:39], v[100:103]
    v_perm_b32 v240, v134, v130, s56
    v_perm_b32 v241, v142, v138, s56
    v_perm_b32 v242, v150, v146, s56
    v_perm_b32 v243, v158, v154, s56
    buffer_load_dwordx4 v[208:211], v2, s[44:47], s64 offen
    s_add_u32 s64, s64, 0x40000
    s_and_b32 s64, s64, 0x3fffff
    v_mfma_f32_16x16x32_bf16 v[104:107], v[244:247], v[32:35], v[104:107]
    v_mfma_f32_16x16x32_bf16 v[108:111], v[244:247], v[36:39], v[108:111]
    v_perm_b32 v244, v134, v130, s57
    v_perm_b32 v245, v142, v138, s57
    v_perm_b32 v246, v150, v146, s57
    v_perm_b32 v247, v158, v154, s57
    buffer_load_dwordx4 v[212:215], v2, s[44:47], s65 offen
    s_add_u32 s65, s65, 0x40000
    s_and_b32 s65, s65, 0x3fffff
    v_mfma_f32_16x16x32_bf16 v[112:115], v[248:251], v[32:35], v[112:115]
    v_mfma_f32_16x16x32_bf16 v[116:119], v[248:251], v[36:39], v[116:119]
    v_perm_b32 v248, v135, v131, s56
    v_perm_b32 v249, v143, v139, s56
    v_perm_b32 v250, v151, v147, s56
    v_perm_b32 v251, v159, v155, s56
    buffer_load_dwordx4 v[216:219], v2, s[44:47], s66 offen
    s_add_u32 s66, s66, 0x40000
    s_and_b32 s66, s66, 0x3fffff
    v_mfma_f32_16x16x32_bf16 v[120:123], v[252:255], v[32:35], v[120:123]
    v_mfma_f32_16x16x32_bf16 v[124:127], v[252:255], v[36:39], v[124:127]
    v_add_u32 v10, s78, v5
    s_add_u32 s78, s78, 0x800
    s_and_b32 s78, s78, 0x7fff
    ds_read_b128 v[32:35], v10 offset:0
    ds_read_b128 v[36:39], v10 offset:1024
    v_perm_b32 v252, v135, v131, s57
    v_perm_b32 v253, v143, v139, s57
    v_perm_b32 v254, v151, v147, s57
    v_perm_b32 v255, v159, v155, s57
    buffer_load_dwordx4 v[220:223], v2, s[44:47], s67 offen
    s_add_u32 s67, s67, 0x40000
    s_and_b32 s67, s67, 0x3fffff
    s_waitcnt lgkmcnt(3)
    v_mfma_f32_16x16x32_bf16 v[64:67], v[224:227], v[40:43], v[64:67]
    s_waitcnt lgkmcnt(2)
    v_mfma_f32_16x16x32_bf16 v[68:71], v[224:227], v[44:47], v[68:71]
    s_waitcnt vmcnt(14)
    v_perm_b32 v224, v164, v160, s56
    s_waitcnt vmcnt(12)
    v_perm_b32 v225, v172, v168, s56
    s_waitcnt vmcnt(10)
    v_perm_b32 v226, v180, v176, s56
    s_waitcnt vmcnt(8)
    v_perm_b32 v227, v188, v184, s56
    buffer_load_dwordx4 v[128:131], v2, s[44:47], s60 offen
    s_add_u32 s60, s60, 0x40000
    s_and_b32 s60, s60, 0x3fffff
    v_mfma_f32_16x16x32_bf16 v[72:75], v[228:231], v[40:43], v[72:75]
    v_mfma_f32_16x16x32_bf16 v[76:79], v[228:231], v[44:47], v[76:79]
    v_perm_b32 v228, v164, v160, s57
    v_perm_b32 v229, v172, v168, s57
    v_perm_b32 v230, v180, v176, s57
    v_perm_b32 v231, v188, v184, s57
    buffer_load_dwordx4 v[132:135], v2, s[44:47], s61 offen
    s_add_u32 s61, s61, 0x40000
    s_and_b32 s61, s61, 0x3fffff
    v_mfma_f32_16x16x32_bf16 v[80:83], v[232:235], v[40:43], v[80:83]
    v_mfma_f32_16x16x32_bf16 v[84:87], v[232:235], v[44:47], v[84:87]
    v_perm_b32 v232, v165, v161, s56
    v_perm_b32 v233, v173, v169, s56
    v_perm_b32 v234, v181, v177, s56
    v_perm_b32 v235, v189, v185, s56
    buffer_load_dwordx4 v[136:139], v2, s[44:47], s62 offen
    s_add_u32 s62, s62, 0x40000
    s_and_b32 s62, s62, 0x3fffff
    v_mfma_f32_16x16x32_bf16 v[88:91], v[236:239], v[40:43], v[88:91]
    v_mfma_f32_16x16x32_bf16 v[92:95], v[236:239], v[44:47], v[92:95]
    v_perm_b32 v236, v165, v161, s57
    v_perm_b32 v237, v173, v169, s57
    v_perm_b32 v238, v181, v177, s57
    v_perm_b32 v239, v189, v185, s57
    buffer_load_dwordx4 v[140:143], v2, s[44:47], s63 offen
    s_add_u32 s63, s63, 0x40000
    s_and_b32 s63, s63, 0x3fffff
    v_mfma_f32_16x16x32_bf16 v[96:99], v[240:243], v[40:43], v[96:99]
    v_mfma_f32_16x16x32_bf16 v[100:103], v[240:243], v[44:47], v[100:103]
    v_perm_b32 v240, v166, v162, s56
    v_perm_b32 v241, v174, v170, s56
    v_perm_b32 v242, v182, v178, s56
    v_perm_b32 v243, v190, v186, s56
    buffer_load_dwordx4 v[144:147], v2, s[44:47], s64 offen
    s_add_u32 s64, s64, 0x40000
    s_and_b32 s64, s64, 0x3fffff
    v_mfma_f32_16x16x32_bf16 v[104:107], v[244:247], v[40:43], v[104:107]
    v_mfma_f32_16x16x32_bf16 v[108:111], v[244:247], v[44:47], v[108:111]
    v_perm_b32 v244, v166, v162, s57
    v_perm_b32 v245, v174, v170, s57
    v_perm_b32 v246, v182, v178, s57
    v_perm_b32 v247, v190, v186, s57
    buffer_load_dwordx4 v[148:151], v2, s[44:47], s65 offen
    s_add_u32 s65, s65, 0x40000
    s_and_b32 s65, s65, 0x3fffff
    v_mfma_f32_16x16x32_bf16 v[112:115], v[248:251], v[40:43], v[112:115]
    v_mfma_f32_16x16x32_bf16 v[116:119], v[248:251], v[44:47], v[116:119]
    v_perm_b32 v248, v167, v163, s56
    v_perm_b32 v249, v175, v171, s56
    v_perm_b32 v250, v183, v179, s56
    v_perm_b32 v251, v191, v187, s56
    buffer_load_dwordx4 v[152:155], v2, s[44:47], s66 offen
    s_add_u32 s66, s66, 0x40000
    s_and_b32 s66, s66, 0x3fffff
    v_mfma_f32_16x16x32_bf16 v[120:123], v[252:255], v[40:43], v[120:123]
    v_mfma_f32_16x16x32_bf16 v[124:127], v[252:255], v[44:47], v[124:127]
    v_add_u32 v15, s78, v5
    s_add_u32 s78, s78, 0x800
    s_and_b32 s78, s78, 0x7fff
    ds_read_b128 v[40:43], v15 offset:0
    ds_read_b128 v[44:47], v15 offset:1024
    v_perm_b32 v252, v167, v163, s57
    v_perm_b32 v253, v175, v171, s57
    v_perm_b32 v254, v183, v179, s57
    v_perm_b32 v255, v191, v187, s57
    buffer_load_dwordx4 v[156:159], v2, s[44:47], s67 offen
    s_add_u32 s67, s67, 0x40000
    s_and_b32 s67, s67, 0x3fffff
    s_waitcnt lgkmcnt(3)
    v_mfma_f32_16x16x32_bf16 v[64:67], v[224:227], v[32:35], v[64:67]
    s_waitcnt lgkmcnt(2)
    v_mfma_f32_16x16x32_bf16 v[68:71], v[224:227], v[36:39], v[68:71]
    s_waitcnt vmcnt(14)
    v_perm_b32 v224, v196, v192, s56
    s_waitcnt vmcnt(12)
    v_perm_b32 v225, v204, v200, s56
    s_waitcnt vmcnt(10)
    v_perm_b32 v226, v212, v208, s56
    s_waitcnt vmcnt(8)
    v_perm_b32 v227, v220, v216, s56
    buffer_load_dwordx4 v[160:163], v2, s[44:47], s60 offen
    s_add_u32 s60, s60, 0x40000
    s_and_b32 s60, s60, 0x3fffff
    v_mfma_f32_16x16x32_bf16 v[72:75], v[228:231], v[32:35], v[72:75]
    v_mfma_f32_16x16x32_bf16 v[76:79], v[228:231], v[36:39], v[76:79]
    v_perm_b32 v228, v196, v192, s57
    v_perm_b32 v229, v204, v200, s57
    v_perm_b32 v230, v212, v208, s57
    v_perm_b32 v231, v220, v216, s57
    buffer_load_dwordx4 v[164:167], v2, s[44:47], s61 offen
    s_add_u32 s61, s61, 0x40000
    s_and_b32 s61, s61, 0x3fffff
    v_mfma_f32_16x16x32_bf16 v[80:83], v[232:235], v[32:35], v[80:83]
    v_mfma_f32_16x16x32_bf16 v[84:87], v[232:235], v[36:39], v[84:87]
    v_perm_b32 v232, v197, v193, s56
    v_perm_b32 v233, v205, v201, s56
    v_perm_b32 v234, v213, v209, s56
    v_perm_b32 v235, v221, v217, s56
    buffer_load_dwordx4 v[168:171], v2, s[44:47], s62 offen
    s_add_u32 s62, s62, 0x40000
    s_and_b32 s62, s62, 0x3fffff
    v_mfma_f32_16x16x32_bf16 v[88:91], v[236:239], v[32:35], v[88:91]
    v_mfma_f32_16x16x32_bf16 v[92:95], v[236:239], v[36:39], v[92:95]
    v_perm_b32 v236, v197, v193, s57
    v_perm_b32 v237, v205, v201, s57
    v_perm_b32 v238, v213, v209, s57
    v_perm_b32 v239, v221, v217, s57
    buffer_load_dwordx4 v[172:175], v2, s[44:47], s63 offen
    s_add_u32 s63, s63, 0x40000
    s_and_b32 s63, s63, 0x3fffff
    v_mfma_f32_16x16x32_bf16 v[96:99], v[240:243], v[32:35], v[96:99]
    v_mfma_f32_16x16x32_bf16 v[100:103], v[240:243], v[36:39], v[100:103]
    v_perm_b32 v240, v198, v194, s56
    v_perm_b32 v241, v206, v202, s56
    v_perm_b32 v242, v214, v210, s56
    v_perm_b32 v243, v222, v218, s56
    buffer_load_dwordx4 v[176:179], v2, s[44:47], s64 offen
    s_add_u32 s64, s64, 0x40000
    s_and_b32 s64, s64, 0x3fffff
    v_mfma_f32_16x16x32_bf16 v[104:107], v[244:247], v[32:35], v[104:107]
    v_mfma_f32_16x16x32_bf16 v[108:111], v[244:247], v[36:39], v[108:111]
    v_perm_b32 v244, v198, v194, s57
    v_perm_b32 v245, v206, v202, s57
    v_perm_b32 v246, v214, v210, s57
    v_perm_b32 v247, v222, v218, s57
    buffer_load_dwordx4 v[180:183], v2, s[44:47], s65 offen
    s_add_u32 s65, s65, 0x40000
    s_and_b32 s65, s65, 0x3fffff
    v_mfma_f32_16x16x32_bf16 v[112:115], v[248:251], v[32:35], v[112:115]
    v_mfma_f32_16x16x32_bf16 v[116:119], v[248:251], v[36:39], v[116:119]
    v_perm_b32 v248, v199, v195, s56
    v_perm_b32 v249, v207, v203, s56
    v_perm_b32 v250, v215, v211, s56
    v_perm_b32 v251, v223, v219, s56
    buffer_load_dwordx4 v[184:187], v2, s[44:47], s66 offen
    s_add_u32 s66, s66, 0x40000
    s_and_b32 s66, s66, 0x3fffff
    v_mfma_f32_16x16x32_bf16 v[120:123], v[252:255], v[32:35], v[120:123]
    v_mfma_f32_16x16x32_bf16 v[124:127], v[252:255], v[36:39], v[124:127]
    v_add_u32 v10, s78, v5
    s_add_u32 s78, s78, 0x800
    s_and_b32 s78, s78, 0x7fff
    ds_read_b128 v[32:35], v10 offset:0
    ds_read_b128 v[36:39], v10 offset:1024
    v_perm_b32 v252, v199, v195, s57
    v_perm_b32 v253, v207, v203, s57
    v_perm_b32 v254, v215, v211, s57
    v_perm_b32 v255, v223, v219, s57
    buffer_load_dwordx4 v[188:191], v2, s[44:47], s67 offen
    s_add_u32 s67, s67, 0x40000
    s_and_b32 s67, s67, 0x3fffff
    s_waitcnt lgkmcnt(3)
    v_mfma_f32_16x16x32_bf16 v[64:67], v[224:227], v[40:43], v[64:67]
    s_waitcnt lgkmcnt(2)
    v_mfma_f32_16x16x32_bf16 v[68:71], v[224:227], v[44:47], v[68:71]
    s_waitcnt vmcnt(14)
    v_perm_b32 v224, v132, v128, s56
    s_waitcnt vmcnt(12)
    v_perm_b32 v225, v140, v136, s56
    s_waitcnt vmcnt(10)
    v_perm_b32 v226, v148, v144, s56
    s_waitcnt vmcnt(8)
    v_perm_b32 v227, v156, v152, s56
    buffer_load_dwordx4 v[192:195], v2, s[44:47], s60 offen
    s_add_u32 s60, s60, 0x40000
    s_and_b32 s60, s60, 0x3fffff
    v_mfma_f32_16x16x32_bf16 v[72:75], v[228:231], v[40:43], v[72:75]
    v_mfma_f32_16x16x32_bf16 v[76:79], v[228:231], v[44:47], v[76:79]
    v_perm_b32 v228, v132, v128, s57
    v_perm_b32 v229, v140, v136, s57
    v_perm_b32 v230, v148, v144, s57
    v_perm_b32 v231, v156, v152, s57
    buffer_load_dwordx4 v[196:199], v2, s[44:47], s61 offen
    s_add_u32 s61, s61, 0x40000
    s_and_b32 s61, s61, 0x3fffff
    v_mfma_f32_16x16x32_bf16 v[80:83], v[232:235], v[40:43], v[80:83]
    v_mfma_f32_16x16x32_bf16 v[84:87], v[232:235], v[44:47], v[84:87]
    v_perm_b32 v232, v133, v129, s56
    v_perm_b32 v233, v141, v137, s56
    v_perm_b32 v234, v149, v145, s56
    v_perm_b32 v235, v157, v153, s56
    buffer_load_dwordx4 v[200:203], v2, s[44:47], s62 offen
    s_add_u32 s62, s62, 0x40000
    s_and_b32 s62, s62, 0x3fffff
    v_mfma_f32_16x16x32_bf16 v[88:91], v[236:239], v[40:43], v[88:91]
    v_mfma_f32_16x16x32_bf16 v[92:95], v[236:239], v[44:47], v[92:95]
    v_perm_b32 v236, v133, v129, s57
    v_perm_b32 v237, v141, v137, s57
    v_perm_b32 v238, v149, v145, s57
    v_perm_b32 v239, v157, v153, s57
    buffer_load_dwordx4 v[204:207], v2, s[44:47], s63 offen
    s_add_u32 s63, s63, 0x40000
    s_and_b32 s63, s63, 0x3fffff
    v_mfma_f32_16x16x32_bf16 v[96:99], v[240:243], v[40:43], v[96:99]
    v_mfma_f32_16x16x32_bf16 v[100:103], v[240:243], v[44:47], v[100:103]
    v_perm_b32 v240, v134, v130, s56
    v_perm_b32 v241, v142, v138, s56
    v_perm_b32 v242, v150, v146, s56
    v_perm_b32 v243, v158, v154, s56
    buffer_load_dwordx4 v[208:211], v2, s[44:47], s64 offen
    s_add_u32 s64, s64, 0x40000
    s_and_b32 s64, s64, 0x3fffff
    v_mfma_f32_16x16x32_bf16 v[104:107], v[244:247], v[40:43], v[104:107]
    v_mfma_f32_16x16x32_bf16 v[108:111], v[244:247], v[44:47], v[108:111]
    v_perm_b32 v244, v134, v130, s57
    v_perm_b32 v245, v142, v138, s57
    v_perm_b32 v246, v150, v146, s57
    v_perm_b32 v247, v158, v154, s57
    buffer_load_dwordx4 v[212:215], v2, s[44:47], s65 offen
    s_add_u32 s65, s65, 0x40000
    s_and_b32 s65, s65, 0x3fffff
    v_mfma_f32_16x16x32_bf16 v[112:115], v[248:251], v[40:43], v[112:115]
    v_mfma_f32_16x16x32_bf16 v[116:119], v[248:251], v[44:47], v[116:119]
    v_perm_b32 v248, v135, v131, s56
    v_perm_b32 v249, v143, v139, s56
    v_perm_b32 v250, v151, v147, s56
    v_perm_b32 v251, v159, v155, s56
    buffer_load_dwordx4 v[216:219], v2, s[44:47], s66 offen
    s_add_u32 s66, s66, 0x40000
    s_and_b32 s66, s66, 0x3fffff
    v_mfma_f32_16x16x32_bf16 v[120:123], v[252:255], v[40:43], v[120:123]
    v_mfma_f32_16x16x32_bf16 v[124:127], v[252:255], v[44:47], v[124:127]
    v_add_u32 v15, s78, v5
    s_add_u32 s78, s78, 0x800
    s_and_b32 s78, s78, 0x7fff
    ds_read_b128 v[40:43], v15 offset:0
    ds_read_b128 v[44:47], v15 offset:1024
    v_perm_b32 v252, v135, v131, s57
    v_perm_b32 v253, v143, v139, s57
    v_perm_b32 v254, v151, v147, s57
    v_perm_b32 v255, v159, v155, s57
    buffer_load_dwordx4 v[220:223], v2, s[44:47], s67 offen
    s_add_u32 s67, s67, 0x40000
    s_and_b32 s67, s67, 0x3fffff
    s_waitcnt lgkmcnt(3)
    v_mfma_f32_16x16x32_bf16 v[64:67], v[224:227], v[32:35], v[64:67]
    s_waitcnt lgkmcnt(2)
    v_mfma_f32_16x16x32_bf16 v[68:71], v[224:227], v[36:39], v[68:71]
    s_waitcnt vmcnt(14)
    v_perm_b32 v224, v164, v160, s56
    s_waitcnt vmcnt(12)
    v_perm_b32 v225, v172, v168, s56
    s_waitcnt vmcnt(10)
    v_perm_b32 v226, v180, v176, s56
    s_waitcnt vmcnt(8)
    v_perm_b32 v227, v188, v184, s56
    buffer_load_dwordx4 v[128:131], v2, s[44:47], s60 offen
    s_add_u32 s60, s60, 0x40000
    s_and_b32 s60, s60, 0x3fffff
    v_mfma_f32_16x16x32_bf16 v[72:75], v[228:231], v[32:35], v[72:75]
    v_mfma_f32_16x16x32_bf16 v[76:79], v[228:231], v[36:39], v[76:79]
    v_perm_b32 v228, v164, v160, s57
    v_perm_b32 v229, v172, v168, s57
    v_perm_b32 v230, v180, v176, s57
    v_perm_b32 v231, v188, v184, s57
    buffer_load_dwordx4 v[132:135], v2, s[44:47], s61 offen
    s_add_u32 s61, s61, 0x40000
    s_and_b32 s61, s61, 0x3fffff
    v_mfma_f32_16x16x32_bf16 v[80:83], v[232:235], v[32:35], v[80:83]
    v_mfma_f32_16x16x32_bf16 v[84:87], v[232:235], v[36:39], v[84:87]
    v_perm_b32 v232, v165, v161, s56
    v_perm_b32 v233, v173, v169, s56
    v_perm_b32 v234, v181, v177, s56
    v_perm_b32 v235, v189, v185, s56
    buffer_load_dwordx4 v[136:139], v2, s[44:47], s62 offen
    s_add_u32 s62, s62, 0x40000
    s_and_b32 s62, s62, 0x3fffff
    v_mfma_f32_16x16x32_bf16 v[88:91], v[236:239], v[32:35], v[88:91]
    v_mfma_f32_16x16x32_bf16 v[92:95], v[236:239], v[36:39], v[92:95]
    v_perm_b32 v236, v165, v161, s57
    v_perm_b32 v237, v173, v169, s57
    v_perm_b32 v238, v181, v177, s57
    v_perm_b32 v239, v189, v185, s57
    buffer_load_dwordx4 v[140:143], v2, s[44:47], s63 offen
    s_add_u32 s63, s63, 0x40000
    s_and_b32 s63, s63, 0x3fffff
    v_mfma_f32_16x16x32_bf16 v[96:99], v[240:243], v[32:35], v[96:99]
    v_mfma_f32_16x16x32_bf16 v[100:103], v[240:243], v[36:39], v[100:103]
    v_perm_b32 v240, v166, v162, s56
    v_perm_b32 v241, v174, v170, s56
    v_perm_b32 v242, v182, v178, s56
    v_perm_b32 v243, v190, v186, s56
    buffer_load_dwordx4 v[144:147], v2, s[44:47], s64 offen
    s_add_u32 s64, s64, 0x40000
    s_and_b32 s64, s64, 0x3fffff
    v_mfma_f32_16x16x32_bf16 v[104:107], v[244:247], v[32:35], v[104:107]
    v_mfma_f32_16x16x32_bf16 v[108:111], v[244:247], v[36:39], v[108:111]
    v_perm_b32 v244, v166, v162, s57
    v_perm_b32 v245, v174, v170, s57
    v_perm_b32 v246, v182, v178, s57
    v_perm_b32 v247, v190, v186, s57
    buffer_load_dwordx4 v[148:151], v2, s[44:47], s65 offen
    s_add_u32 s65, s65, 0x40000
    s_and_b32 s65, s65, 0x3fffff
    v_mfma_f32_16x16x32_bf16 v[112:115], v[248:251], v[32:35], v[112:115]
    v_mfma_f32_16x16x32_bf16 v[116:119], v[248:251], v[36:39], v[116:119]
    v_perm_b32 v248, v167, v163, s56
    v_perm_b32 v249, v175, v171, s56
    v_perm_b32 v250, v183, v179, s56
    v_perm_b32 v251, v191, v187, s56
    buffer_load_dwordx4 v[152:155], v2, s[44:47], s66 offen
    s_add_u32 s66, s66, 0x40000
    s_and_b32 s66, s66, 0x3fffff
    v_mfma_f32_16x16x32_bf16 v[120:123], v[252:255], v[32:35], v[120:123]
    v_mfma_f32_16x16x32_bf16 v[124:127], v[252:255], v[36:39], v[124:127]
    v_add_u32 v10, s78, v5
    s_add_u32 s78, s78, 0x800
    s_and_b32 s78, s78, 0x7fff
    ds_read_b128 v[32:35], v10 offset:0
    ds_read_b128 v[36:39], v10 offset:1024
    v_perm_b32 v252, v167, v163, s57
    v_perm_b32 v253, v175, v171, s57
    v_perm_b32 v254, v183, v179, s57
    v_perm_b32 v255, v191, v187, s57
    buffer_load_dwordx4 v[156:159], v2, s[44:47], s67 offen
    s_add_u32 s67, s67, 0x40000
    s_and_b32 s67, s67, 0x3fffff
    s_waitcnt lgkmcnt(3)
    v_mfma_f32_16x16x32_bf16 v[64:67], v[224:227], v[40:43], v[64:67]
    s_waitcnt lgkmcnt(2)
    v_mfma_f32_16x16x32_bf16 v[68:71], v[224:227], v[44:47], v[68:71]
    s_waitcnt vmcnt(14)
    v_perm_b32 v224, v196, v192, s56
    s_waitcnt vmcnt(12)
    v_perm_b32 v225, v204, v200, s56
    s_waitcnt vmcnt(10)
    v_perm_b32 v226, v212, v208, s56
    s_waitcnt vmcnt(8)
    v_perm_b32 v227, v220, v216, s56
    v_mfma_f32_16x16x32_bf16 v[72:75], v[228:231], v[40:43], v[72:75]
    v_mfma_f32_16x16x32_bf16 v[76:79], v[228:231], v[44:47], v[76:79]
    v_perm_b32 v228, v196, v192, s57
    v_perm_b32 v229, v204, v200, s57
    v_perm_b32 v230, v212, v208, s57
    v_perm_b32 v231, v220, v216, s57
    v_mfma_f32_16x16x32_bf16 v[80:83], v[232:235], v[40:43], v[80:83]
    v_mfma_f32_16x16x32_bf16 v[84:87], v[232:235], v[44:47], v[84:87]
    v_perm_b32 v232, v197, v193, s56
    v_perm_b32 v233, v205, v201, s56
    v_perm_b32 v234, v213, v209, s56
    v_perm_b32 v235, v221, v217, s56
    v_mfma_f32_16x16x32_bf16 v[88:91], v[236:239], v[40:43], v[88:91]
    v_mfma_f32_16x16x32_bf16 v[92:95], v[236:239], v[44:47], v[92:95]
    v_perm_b32 v236, v197, v193, s57
    v_perm_b32 v237, v205, v201, s57
    v_perm_b32 v238, v213, v209, s57
    v_perm_b32 v239, v221, v217, s57
    v_mfma_f32_16x16x32_bf16 v[96:99], v[240:243], v[40:43], v[96:99]
    v_mfma_f32_16x16x32_bf16 v[100:103], v[240:243], v[44:47], v[100:103]
    v_perm_b32 v240, v198, v194, s56
    v_perm_b32 v241, v206, v202, s56
    v_perm_b32 v242, v214, v210, s56
    v_perm_b32 v243, v222, v218, s56
    v_mfma_f32_16x16x32_bf16 v[104:107], v[244:247], v[40:43], v[104:107]
    v_mfma_f32_16x16x32_bf16 v[108:111], v[244:247], v[44:47], v[108:111]
    v_perm_b32 v244, v198, v194, s57
    v_perm_b32 v245, v206, v202, s57
    v_perm_b32 v246, v214, v210, s57
    v_perm_b32 v247, v222, v218, s57
    v_mfma_f32_16x16x32_bf16 v[112:115], v[248:251], v[40:43], v[112:115]
    v_mfma_f32_16x16x32_bf16 v[116:119], v[248:251], v[44:47], v[116:119]
    v_perm_b32 v248, v199, v195, s56
    v_perm_b32 v249, v207, v203, s56
    v_perm_b32 v250, v215, v211, s56
    v_perm_b32 v251, v223, v219, s56
    v_mfma_f32_16x16x32_bf16 v[120:123], v[252:255], v[40:43], v[120:123]
    v_mfma_f32_16x16x32_bf16 v[124:127], v[252:255], v[44:47], v[124:127]
    v_add_u32 v15, s78, v5
    s_add_u32 s78, s78, 0x800
    s_and_b32 s78, s78, 0x7fff
    ds_read_b128 v[40:43], v15 offset:0
    ds_read_b128 v[44:47], v15 offset:1024
    v_perm_b32 v252, v199, v195, s57
    v_perm_b32 v253, v207, v203, s57
    v_perm_b32 v254, v215, v211, s57
    v_perm_b32 v255, v223, v219, s57
    s_waitcnt lgkmcnt(3)
    v_mfma_f32_16x16x32_bf16 v[64:67], v[224:227], v[32:35], v[64:67]
    s_waitcnt lgkmcnt(2)
    v_mfma_f32_16x16x32_bf16 v[68:71], v[224:227], v[36:39], v[68:71]
    s_waitcnt vmcnt(6)
    v_perm_b32 v224, v132, v128, s56
    s_waitcnt vmcnt(4)
    v_perm_b32 v225, v140, v136, s56
    s_waitcnt vmcnt(2)
    v_perm_b32 v226, v148, v144, s56
    s_waitcnt vmcnt(0)
    v_perm_b32 v227, v156, v152, s56
    v_mfma_f32_16x16x32_bf16 v[72:75], v[228:231], v[32:35], v[72:75]
    v_mfma_f32_16x16x32_bf16 v[76:79], v[228:231], v[36:39], v[76:79]
    v_perm_b32 v228, v132, v128, s57
    v_perm_b32 v229, v140, v136, s57
    v_perm_b32 v230, v148, v144, s57
    v_perm_b32 v231, v156, v152, s57
    v_mfma_f32_16x16x32_bf16 v[80:83], v[232:235], v[32:35], v[80:83]
    v_mfma_f32_16x16x32_bf16 v[84:87], v[232:235], v[36:39], v[84:87]
    v_perm_b32 v232, v133, v129, s56
    v_perm_b32 v233, v141, v137, s56
    v_perm_b32 v234, v149, v145, s56
    v_perm_b32 v235, v157, v153, s56
    v_mfma_f32_16x16x32_bf16 v[88:91], v[236:239], v[32:35], v[88:91]
    v_mfma_f32_16x16x32_bf16 v[92:95], v[236:239], v[36:39], v[92:95]
    v_perm_b32 v236, v133, v129, s57
    v_perm_b32 v237, v141, v137, s57
    v_perm_b32 v238, v149, v145, s57
    v_perm_b32 v239, v157, v153, s57
    v_mfma_f32_16x16x32_bf16 v[96:99], v[240:243], v[32:35], v[96:99]
    v_mfma_f32_16x16x32_bf16 v[100:103], v[240:243], v[36:39], v[100:103]
    v_perm_b32 v240, v134, v130, s56
    v_perm_b32 v241, v142, v138, s56
    v_perm_b32 v242, v150, v146, s56
    v_perm_b32 v243, v158, v154, s56
    v_mfma_f32_16x16x32_bf16 v[104:107], v[244:247], v[32:35], v[104:107]
    v_mfma_f32_16x16x32_bf16 v[108:111], v[244:247], v[36:39], v[108:111]
    v_perm_b32 v244, v134, v130, s57
    v_perm_b32 v245, v142, v138, s57
    v_perm_b32 v246, v150, v146, s57
    v_perm_b32 v247, v158, v154, s57
    v_mfma_f32_16x16x32_bf16 v[112:115], v[248:251], v[32:35], v[112:115]
    v_mfma_f32_16x16x32_bf16 v[116:119], v[248:251], v[36:39], v[116:119]
    v_perm_b32 v248, v135, v131, s56
    v_perm_b32 v249, v143, v139, s56
    v_perm_b32 v250, v151, v147, s56
    v_perm_b32 v251, v159, v155, s56
    v_mfma_f32_16x16x32_bf16 v[120:123], v[252:255], v[32:35], v[120:123]
    v_mfma_f32_16x16x32_bf16 v[124:127], v[252:255], v[36:39], v[124:127]
    v_perm_b32 v252, v135, v131, s57
    v_perm_b32 v253, v143, v139, s57
    v_perm_b32 v254, v151, v147, s57
    v_perm_b32 v255, v159, v155, s57
    s_waitcnt lgkmcnt(1)
    v_mfma_f32_16x16x32_bf16 v[64:67], v[224:227], v[40:43], v[64:67]
    s_waitcnt lgkmcnt(0)
    v_mfma_f32_16x16x32_bf16 v[68:71], v[224:227], v[44:47], v[68:71]
    v_mfma_f32_16x16x32_bf16 v[72:75], v[228:231], v[40:43], v[72:75]
    v_mfma_f32_16x16x32_bf16 v[76:79], v[228:231], v[44:47], v[76:79]
    v_mfma_f32_16x16x32_bf16 v[80:83], v[232:235], v[40:43], v[80:83]
    v_mfma_f32_16x16x32_bf16 v[84:87], v[232:235], v[44:47], v[84:87]
    v_mfma_f32_16x16x32_bf16 v[88:91], v[236:239], v[40:43], v[88:91]
    v_mfma_f32_16x16x32_bf16 v[92:95], v[236:239], v[44:47], v[92:95]
    v_mfma_f32_16x16x32_bf16 v[96:99], v[240:243], v[40:43], v[96:99]
    v_mfma_f32_16x16x32_bf16 v[100:103], v[240:243], v[44:47], v[100:103]
    v_mfma_f32_16x16x32_bf16 v[104:107], v[244:247], v[40:43], v[104:107]
    v_mfma_f32_16x16x32_bf16 v[108:111], v[244:247], v[44:47], v[108:111]
    v_mfma_f32_16x16x32_bf16 v[112:115], v[248:251], v[40:43], v[112:115]
    v_mfma_f32_16x16x32_bf16 v[116:119], v[248:251], v[44:47], v[116:119]
    v_mfma_f32_16x16x32_bf16 v[120:123], v[252:255], v[40:43], v[120:123]
    v_mfma_f32_16x16x32_bf16 v[124:127], v[252:255], v[44:47], v[124:127]
    v_mul_f32 v64, s58, v64
    v_mul_f32 v72, s58, v72
    v_cvt_pk_bf16_f32 v32, v64, v72
    v_mul_f32 v80, s58, v80
    v_mul_f32 v88, s58, v88
    v_cvt_pk_bf16_f32 v33, v80, v88
    v_mul_f32 v96, s58, v96
    v_mul_f32 v104, s58, v104
    v_cvt_pk_bf16_f32 v34, v96, v104
    v_mul_f32 v112, s58, v112
    s_nop 0
    v_mul_f32 v120, s58, v120
    v_cvt_pk_bf16_f32 v35, v112, v120
    v_mul_f32 v68, s58, v68
    v_mul_f32 v76, s58, v76
    v_cvt_pk_bf16_f32 v48, v68, v76
    v_mul_f32 v84, s58, v84
    v_mul_f32 v92, s58, v92
    v_cvt_pk_bf16_f32 v49, v84, v92
    v_mul_f32 v100, s58, v100
    v_mul_f32 v108, s58, v108
    v_cvt_pk_bf16_f32 v50, v100, v108
    v_mul_f32 v116, s58, v116
    v_mul_f32 v124, s58, v124
    v_cvt_pk_bf16_f32 v51, v116, v124
    v_mul_f32 v65, s58, v65
    v_mul_f32 v73, s58, v73
    v_cvt_pk_bf16_f32 v36, v65, v73
    v_mul_f32 v81, s58, v81
    v_mul_f32 v89, s58, v89
    v_cvt_pk_bf16_f32 v37, v81, v89
    v_mul_f32 v97, s58, v97
    v_mul_f32 v105, s58, v105
    v_cvt_pk_bf16_f32 v38, v97, v105
    v_mul_f32 v113, s58, v113
    v_mul_f32 v121, s58, v121
    v_cvt_pk_bf16_f32 v39, v113, v121
    v_mul_f32 v69, s58, v69
    v_mul_f32 v77, s58, v77
    v_cvt_pk_bf16_f32 v52, v69, v77
    v_mul_f32 v85, s58, v85
    v_mul_f32 v93, s58, v93
    v_cvt_pk_bf16_f32 v53, v85, v93
    v_mul_f32 v101, s58, v101
    v_mul_f32 v109, s58, v109
    v_cvt_pk_bf16_f32 v54, v101, v109
    v_mul_f32 v117, s58, v117
    v_mul_f32 v125, s58, v125
    v_cvt_pk_bf16_f32 v55, v117, v125
    v_mul_f32 v66, s58, v66
    v_mul_f32 v74, s58, v74
    v_cvt_pk_bf16_f32 v40, v66, v74
    v_mul_f32 v82, s58, v82
    v_mul_f32 v90, s58, v90
    v_cvt_pk_bf16_f32 v41, v82, v90
    v_mul_f32 v98, s58, v98
    v_mul_f32 v106, s58, v106
    v_cvt_pk_bf16_f32 v42, v98, v106
    v_mul_f32 v114, s58, v114
    v_mul_f32 v122, s58, v122
    v_cvt_pk_bf16_f32 v43, v114, v122
    v_mul_f32 v70, s58, v70
    v_mul_f32 v78, s58, v78
    v_cvt_pk_bf16_f32 v56, v70, v78
    v_mul_f32 v86, s58, v86
    v_mul_f32 v94, s58, v94
    v_cvt_pk_bf16_f32 v57, v86, v94
    v_mul_f32 v102, s58, v102
    v_mul_f32 v110, s58, v110
    v_cvt_pk_bf16_f32 v58, v102, v110
    v_mul_f32 v118, s58, v118
    v_mul_f32 v126, s58, v126
    v_cvt_pk_bf16_f32 v59, v118, v126
    v_mul_f32 v67, s58, v67
    v_mul_f32 v75, s58, v75
    v_cvt_pk_bf16_f32 v44, v67, v75
    v_mul_f32 v83, s58, v83
    v_mul_f32 v91, s58, v91
    v_cvt_pk_bf16_f32 v45, v83, v91
    v_mul_f32 v99, s58, v99
    v_mul_f32 v107, s58, v107
    v_cvt_pk_bf16_f32 v46, v99, v107
    v_mul_f32 v115, s58, v115
    v_mul_f32 v123, s58, v123
    v_cvt_pk_bf16_f32 v47, v115, v123
    v_mul_f32 v71, s58, v71
    v_mul_f32 v79, s58, v79
    v_cvt_pk_bf16_f32 v60, v71, v79
    v_mul_f32 v87, s58, v87
    v_mul_f32 v95, s58, v95
    v_cvt_pk_bf16_f32 v61, v87, v95
    v_mul_f32 v103, s58, v103
    v_mul_f32 v111, s58, v111
    v_cvt_pk_bf16_f32 v62, v103, v111
    v_mul_f32 v119, s58, v119
    v_mul_f32 v127, s58, v127
    v_cvt_pk_bf16_f32 v63, v119, v127
    v_permlane16_swap_b32 v32, v48
    v_permlane16_swap_b32 v33, v49
    v_permlane16_swap_b32 v34, v50
    v_permlane16_swap_b32 v35, v51
    v_permlane16_swap_b32 v36, v52
    v_permlane16_swap_b32 v37, v53
    v_permlane16_swap_b32 v38, v54
    v_permlane16_swap_b32 v39, v55
    v_permlane16_swap_b32 v40, v56
    v_permlane16_swap_b32 v41, v57
    v_permlane16_swap_b32 v42, v58
    v_permlane16_swap_b32 v43, v59
    v_permlane16_swap_b32 v44, v60
    v_permlane16_swap_b32 v45, v61
    v_permlane16_swap_b32 v46, v62
    v_permlane16_swap_b32 v47, v63
    v_and_b32 v16, 31, v1
    v_lshrrev_b32 v17, 5, v1
    v_lshrrev_b32 v18, 4, v1
    v_and_b32 v18, 1, v18
    v_lshrrev_b32 v19, 2, v1
    v_and_b32 v19, 3, v19
    v_and_b32 v20, 3, v1
    v_lshrrev_b32 v21, 1, v20
    v_xor_b32 v21, v21, v17
    v_lshlrev_b32 v22, 2, v19
    v_or_b32 v21, v21, v22
    v_lshlrev_b32 v22, 1, v18
    v_or_b32 v21, v21, v22
    v_lshlrev_b32 v21, 4, v21
    v_and_b32 v20, 1, v20
    v_lshlrev_b32 v20, 3, v20
    v_or_b32 v21, v21, v20
    v_lshlrev_b32 v22, 2, v17
    v_add_u32 v22, v22, v19
    v_lshlrev_b32 v22, 8, v22
    v_add_u32 v21, v21, v22
    v_add_u32 v21, 0x10000, v21
    v_xor_b32 v24, 0x0, v21
    v_xor_b32 v25, 0x20, v21
    v_xor_b32 v26, 0x40, v21
    v_xor_b32 v27, 0x60, v21
    v_xor_b32 v28, 0x80, v21
    v_xor_b32 v29, 0xa0, v21
    v_xor_b32 v30, 0xc0, v21
    v_xor_b32 v31, 0xe0, v21
    v_and_b32 v18, 15, v16
    v_lshlrev_b32 v19, 3, v17
    v_xor_b32 v18, v18, v19
    v_lshlrev_b32 v18, 4, v18
    v_lshlrev_b32 v19, 8, v16
    v_add_u32 v15, v18, v19
    v_xor_b32 v16, 0x0, v15
    v_xor_b32 v17, 0x10, v15
    v_xor_b32 v18, 0x20, v15
    v_xor_b32 v19, 0x30, v15
    v_xor_b32 v20, 0x40, v15
    v_xor_b32 v21, 0x50, v15
    v_xor_b32 v22, 0x60, v15
    v_xor_b32 v23, 0x70, v15
    s_barrier
    ds_read_b128 v[192:195], v16 offset:0
    ds_read_b128 v[196:199], v17 offset:0
    ds_read_b128 v[200:203], v18 offset:0
    ds_read_b128 v[204:207], v19 offset:0
    ds_read_b128 v[208:211], v20 offset:0
    s_waitcnt lgkmcnt(3)
    v_mfma_f32_32x32x16_bf16 v[128:143], v[192:195], v[32:35], 0
    ds_read_b128 v[212:215], v21 offset:0
    v_mfma_f32_32x32x16_bf16 v[128:143], v[196:199], v[36:39], v[128:143]
    ds_read_b128 v[216:219], v22 offset:0
    s_waitcnt lgkmcnt(3)
    v_mfma_f32_32x32x16_bf16 v[128:143], v[200:203], v[40:43], v[128:143]
    ds_read_b128 v[220:223], v23 offset:0
    v_mfma_f32_32x32x16_bf16 v[128:143], v[204:207], v[44:47], v[128:143]
    ds_read_b128 v[192:195], v16 offset:8192
    s_waitcnt lgkmcnt(3)
    v_mfma_f32_32x32x16_bf16 v[128:143], v[208:211], v[48:51], v[128:143]
    ds_read_b128 v[196:199], v17 offset:8192
    v_mfma_f32_32x32x16_bf16 v[128:143], v[212:215], v[52:55], v[128:143]
    ds_read_b128 v[200:203], v18 offset:8192
    s_waitcnt lgkmcnt(3)
    v_mfma_f32_32x32x16_bf16 v[128:143], v[216:219], v[56:59], v[128:143]
    ds_read_b128 v[204:207], v19 offset:8192
    v_mfma_f32_32x32x16_bf16 v[128:143], v[220:223], v[60:63], v[128:143]
    ds_read_b128 v[208:211], v20 offset:8192
    s_waitcnt lgkmcnt(3)
    v_mfma_f32_32x32x16_bf16 v[144:159], v[192:195], v[32:35], 0
    ds_read_b128 v[212:215], v21 offset:8192
    v_mfma_f32_32x32x16_bf16 v[144:159], v[196:199], v[36:39], v[144:159]
    ds_read_b128 v[216:219], v22 offset:8192
    s_waitcnt lgkmcnt(3)
    v_mfma_f32_32x32x16_bf16 v[144:159], v[200:203], v[40:43], v[144:159]
    ds_read_b128 v[220:223], v23 offset:8192
    v_mfma_f32_32x32x16_bf16 v[144:159], v[204:207], v[44:47], v[144:159]
    ds_read_b128 v[192:195], v16 offset:16384
    s_waitcnt lgkmcnt(3)
    v_mfma_f32_32x32x16_bf16 v[144:159], v[208:211], v[48:51], v[144:159]
    ds_read_b128 v[196:199], v17 offset:16384
    v_mfma_f32_32x32x16_bf16 v[144:159], v[212:215], v[52:55], v[144:159]
    ds_read_b128 v[200:203], v18 offset:16384
    s_waitcnt lgkmcnt(3)
    v_mfma_f32_32x32x16_bf16 v[144:159], v[216:219], v[56:59], v[144:159]
    ds_read_b128 v[204:207], v19 offset:16384
    v_mfma_f32_32x32x16_bf16 v[144:159], v[220:223], v[60:63], v[144:159]
    ds_read_b128 v[208:211], v20 offset:16384
    s_barrier
    v_max3_f32 v10, v128, v129, v130
    s_nop 8
    v_max3_f32 v15, v144, v145, v146
    v_max3_f32 v10, v10, v131, v132
    v_max3_f32 v15, v15, v147, v148
    v_max3_f32 v10, v10, v133, v134
    v_max3_f32 v15, v15, v149, v150
    v_max3_f32 v10, v10, v135, v136
    v_max3_f32 v15, v15, v151, v152
    v_max3_f32 v10, v10, v137, v138
    v_max3_f32 v15, v15, v153, v154
    v_max3_f32 v10, v10, v139, v140
    v_max3_f32 v15, v15, v155, v156
    v_max3_f32 v10, v10, v141, v142
    v_max3_f32 v15, v15, v157, v158
    v_max3_f32 v10, v10, v143, v159
    v_max_f32 v10, v10, v15
    v_mov_b32 v15, v10
    s_nop 1
    v_permlane32_swap_b32 v10, v15
    v_max_f32 v10, v10, v15
    v_sub_f32 v224, 0, v10
    v_sub_f32 v225, 0, v10
    v_sub_f32 v226, 0, v10
    v_sub_f32 v227, 0, v10
    v_sub_f32 v228, 0, v10
    v_sub_f32 v229, 0, v10
    v_sub_f32 v230, 0, v10
    v_sub_f32 v231, 0, v10
    v_sub_f32 v232, 0, v10
    v_sub_f32 v233, 0, v10
    v_sub_f32 v234, 0, v10
    v_sub_f32 v235, 0, v10
    v_sub_f32 v236, 0, v10
    v_sub_f32 v237, 0, v10
    v_sub_f32 v238, 0, v10
    v_sub_f32 v239, 0, v10
    s_waitcnt lgkmcnt(3)
    s_nop 0
    v_mfma_f32_32x32x16_bf16 v[160:175], v[192:195], v[32:35], v[224:239]
    ds_read_b128 v[212:215], v21 offset:16384
    v_mfma_f32_32x32x16_bf16 v[160:175], v[196:199], v[36:39], v[160:175]
    ds_read_b128 v[216:219], v22 offset:16384
    s_waitcnt lgkmcnt(3)
    v_mfma_f32_32x32x16_bf16 v[160:175], v[200:203], v[40:43], v[160:175]
    ds_read_b128 v[220:223], v23 offset:16384
    v_mfma_f32_32x32x16_bf16 v[160:175], v[204:207], v[44:47], v[160:175]
    ds_read_b128 v[192:195], v16 offset:24576
    v_sub_f32 v128, v128, v10
    v_exp_f32 v128, v128
    v_sub_f32 v129, v129, v10
    v_exp_f32 v129, v129
    v_sub_f32 v130, v130, v10
    v_exp_f32 v130, v130
    s_waitcnt lgkmcnt(3)
    v_mfma_f32_32x32x16_bf16 v[160:175], v[208:211], v[48:51], v[160:175]
    ds_read_b128 v[196:199], v17 offset:24576
    v_cvt_pk_bf16_f32 v128, v128, v129
    v_sub_f32 v131, v131, v10
    v_exp_f32 v131, v131
    v_sub_f32 v132, v132, v10
    v_exp_f32 v132, v132
    v_cvt_pk_bf16_f32 v129, v130, v131
    v_sub_f32 v133, v133, v10
    v_exp_f32 v133, v133
    v_mfma_f32_32x32x16_bf16 v[160:175], v[212:215], v[52:55], v[160:175]
    ds_read_b128 v[200:203], v18 offset:24576
    v_sub_f32 v134, v134, v10
    v_exp_f32 v134, v134
    v_cvt_pk_bf16_f32 v130, v132, v133
    v_sub_f32 v135, v135, v10
    v_exp_f32 v135, v135
    v_dot2_f32_bf16 v248, v128, s69, 0
    v_cvt_pk_bf16_f32 v131, v134, v135
    v_dot2_f32_bf16 v249, v129, s69, 0
    s_waitcnt lgkmcnt(3)
    v_mfma_f32_32x32x16_bf16 v[160:175], v[216:219], v[56:59], v[160:175]
    ds_read_b128 v[204:207], v19 offset:24576
    v_dot2_f32_bf16 v250, v130, s69, 0
    v_dot2_f32_bf16 v251, v131, s69, 0
    v_sub_f32 v136, v136, v10
    v_exp_f32 v136, v136
    v_sub_f32 v137, v137, v10
    v_exp_f32 v137, v137
    v_sub_f32 v138, v138, v10
    v_exp_f32 v138, v138
    v_mfma_f32_32x32x16_bf16 v[160:175], v[220:223], v[60:63], v[160:175]
    ds_read_b128 v[208:211], v20 offset:24576
    v_cvt_pk_bf16_f32 v136, v136, v137
    v_sub_f32 v139, v139, v10
    v_exp_f32 v139, v139
    v_sub_f32 v140, v140, v10
    v_exp_f32 v140, v140
    v_cvt_pk_bf16_f32 v137, v138, v139
    v_sub_f32 v141, v141, v10
    v_exp_f32 v141, v141
    s_waitcnt lgkmcnt(3)
    v_mfma_f32_32x32x16_bf16 v[176:191], v[192:195], v[32:35], v[224:239]
    ds_read_b128 v[212:215], v21 offset:24576
    v_sub_f32 v142, v142, v10
    v_exp_f32 v142, v142
    v_cvt_pk_bf16_f32 v138, v140, v141
    v_sub_f32 v143, v143, v10
    v_exp_f32 v143, v143
    v_dot2_f32_bf16 v248, v136, s69, v248
    v_cvt_pk_bf16_f32 v139, v142, v143
    v_dot2_f32_bf16 v249, v137, s69, v249
    v_dot2_f32_bf16 v250, v138, s69, v250
    v_mfma_f32_32x32x16_bf16 v[176:191], v[196:199], v[36:39], v[176:191]
    ds_read_b128 v[216:219], v22 offset:24576
    v_dot2_f32_bf16 v251, v139, s69, v251
    v_sub_f32 v144, v144, v10
    v_exp_f32 v144, v144
    v_sub_f32 v145, v145, v10
    v_exp_f32 v145, v145
    v_sub_f32 v146, v146, v10
    v_exp_f32 v146, v146
    v_cvt_pk_bf16_f32 v144, v144, v145
    s_waitcnt lgkmcnt(3)
    v_mfma_f32_32x32x16_bf16 v[176:191], v[200:203], v[40:43], v[176:191]
    ds_read_b128 v[220:223], v23 offset:24576
    v_sub_f32 v147, v147, v10
    v_exp_f32 v147, v147
    v_sub_f32 v148, v148, v10
    v_exp_f32 v148, v148
    v_cvt_pk_bf16_f32 v145, v146, v147
    v_sub_f32 v149, v149, v10
    v_exp_f32 v149, v149
    v_sub_f32 v150, v150, v10
    v_mfma_f32_32x32x16_bf16 v[176:191], v[204:207], v[44:47], v[176:191]
    ds_read_b64_tr_b16 v[192:193], v24 offset:0
    ds_read_b64_tr_b16 v[194:195], v25 offset:2048
    v_exp_f32 v150, v150
    v_cvt_pk_bf16_f32 v146, v148, v149
    v_sub_f32 v151, v151, v10
    v_exp_f32 v151, v151
    v_dot2_f32_bf16 v248, v144, s69, v248
    v_cvt_pk_bf16_f32 v147, v150, v151
    v_dot2_f32_bf16 v249, v145, s69, v249
    v_dot2_f32_bf16 v250, v146, s69, v250
    s_waitcnt lgkmcnt(4)
    v_mfma_f32_32x32x16_bf16 v[176:191], v[208:211], v[48:51], v[176:191]
    ds_read_b64_tr_b16 v[196:197], v26 offset:0
    ds_read_b64_tr_b16 v[198:199], v27 offset:2048
    v_dot2_f32_bf16 v251, v147, s69, v251
    v_sub_f32 v152, v152, v10
    v_exp_f32 v152, v152
    v_sub_f32 v153, v153, v10
    v_exp_f32 v153, v153
    v_sub_f32 v154, v154, v10
    v_exp_f32 v154, v154
    v_cvt_pk_bf16_f32 v152, v152, v153
    v_mfma_f32_32x32x16_bf16 v[176:191], v[212:215], v[52:55], v[176:191]
    ds_read_b64_tr_b16 v[200:201], v28 offset:0
    ds_read_b64_tr_b16 v[202:203], v29 offset:2048
    v_sub_f32 v155, v155, v10
    v_exp_f32 v155, v155
    v_sub_f32 v156, v156, v10
    v_exp_f32 v156, v156
    v_cvt_pk_bf16_f32 v153, v154, v155
    v_sub_f32 v157, v157, v10
    v_exp_f32 v157, v157
    v_sub_f32 v158, v158, v10
    s_waitcnt lgkmcnt(6)
    v_mfma_f32_32x32x16_bf16 v[176:191], v[216:219], v[56:59], v[176:191]
    ds_read_b64_tr_b16 v[204:205], v30 offset:0
    ds_read_b64_tr_b16 v[206:207], v31 offset:2048
    v_exp_f32 v158, v158
    v_cvt_pk_bf16_f32 v154, v156, v157
    v_sub_f32 v159, v159, v10
    v_exp_f32 v159, v159
    v_dot2_f32_bf16 v248, v152, s69, v248
    v_cvt_pk_bf16_f32 v155, v158, v159
    v_dot2_f32_bf16 v249, v153, s69, v249
    v_dot2_f32_bf16 v250, v154, s69, v250
    v_dot2_f32_bf16 v251, v155, s69, v251
    v_mfma_f32_32x32x16_bf16 v[176:191], v[220:223], v[60:63], v[176:191]
    ds_read_b64_tr_b16 v[208:209], v24 offset:4096
    ds_read_b64_tr_b16 v[210:211], v25 offset:6144
    s_barrier
    s_waitcnt lgkmcnt(6)
    v_mfma_f32_32x32x16_bf16 v[64:79], v[192:195], v[128:131], 0
    ds_read_b64_tr_b16 v[212:213], v26 offset:4096
    ds_read_b64_tr_b16 v[214:215], v27 offset:6144
    v_max3_f32 v10, v160, v161, v162
    s_nop 3
    v_max3_f32 v15, v176, v177, v178
    v_max3_f32 v10, v10, v163, v164
    v_max3_f32 v15, v15, v179, v180
    v_mfma_f32_32x32x16_bf16 v[80:95], v[196:199], v[128:131], 0
    ds_read_b64_tr_b16 v[216:217], v28 offset:4096
    ds_read_b64_tr_b16 v[218:219], v29 offset:6144
    v_max3_f32 v10, v10, v165, v166
    v_max3_f32 v15, v15, v181, v182
    v_max3_f32 v10, v10, v167, v168
    s_waitcnt lgkmcnt(6)
    v_mfma_f32_32x32x16_bf16 v[96:111], v[200:203], v[128:131], 0
    ds_read_b64_tr_b16 v[220:221], v30 offset:4096
    ds_read_b64_tr_b16 v[222:223], v31 offset:6144
    v_max3_f32 v15, v15, v183, v184
    v_max3_f32 v10, v10, v169, v170
    v_max3_f32 v15, v15, v185, v186
    v_max3_f32 v10, v10, v171, v172
    v_mfma_f32_32x32x16_bf16 v[112:127], v[204:207], v[128:131], 0
    ds_read_b64_tr_b16 v[192:193], v24 offset:8192
    ds_read_b64_tr_b16 v[194:195], v25 offset:10240
    v_max3_f32 v15, v15, v187, v188
    v_max3_f32 v10, v10, v173, v174
    v_max3_f32 v15, v15, v189, v190
    v_max3_f32 v10, v10, v175, v191
    s_waitcnt lgkmcnt(6)
    v_mfma_f32_32x32x16_bf16 v[64:79], v[208:211], v[136:139], v[64:79]
    ds_read_b64_tr_b16 v[196:197], v26 offset:8192
    ds_read_b64_tr_b16 v[198:199], v27 offset:10240
    v_max_f32 v10, v10, v15
    v_cmp_lt_f32 vcc, s59, v10
    s_cbranch_vccz L_noupd1
    s_nop 2
    v_mov_b32 v15, v10
    s_nop 1
    v_permlane32_swap_b32 v10, v15
    v_max_f32 v10, v10, v15
    v_cmp_lt_f32 vcc, s59, v10
    s_nop 1
    v_cndmask_b32 v10, 0, v10, vcc
    v_exp_f32 v9, -v10
    v_sub_f32 v160, v160, v10
    v_sub_f32 v161, v161, v10
    v_sub_f32 v162, v162, v10
    v_sub_f32 v163, v163, v10
    v_sub_f32 v164, v164, v10
    v_sub_f32 v165, v165, v10
    v_sub_f32 v166, v166, v10
    v_sub_f32 v167, v167, v10
    v_sub_f32 v168, v168, v10
    v_sub_f32 v169, v169, v10
    v_sub_f32 v170, v170, v10
    v_sub_f32 v171, v171, v10
    v_sub_f32 v172, v172, v10
    v_sub_f32 v173, v173, v10
    v_sub_f32 v174, v174, v10
    v_sub_f32 v175, v175, v10
    v_sub_f32 v176, v176, v10
    v_sub_f32 v177, v177, v10
    v_sub_f32 v178, v178, v10
    v_sub_f32 v179, v179, v10
    v_sub_f32 v180, v180, v10
    v_sub_f32 v181, v181, v10
    v_sub_f32 v182, v182, v10
    v_sub_f32 v183, v183, v10
    v_sub_f32 v184, v184, v10
    v_sub_f32 v185, v185, v10
    v_sub_f32 v186, v186, v10
    v_sub_f32 v187, v187, v10
    v_sub_f32 v188, v188, v10
    v_sub_f32 v189, v189, v10
    v_sub_f32 v190, v190, v10
    v_sub_f32 v191, v191, v10
    v_sub_f32 v224, v224, v10
    v_sub_f32 v225, v225, v10
    v_sub_f32 v226, v226, v10
    v_sub_f32 v227, v227, v10
    v_sub_f32 v228, v228, v10
    v_sub_f32 v229, v229, v10
    v_sub_f32 v230, v230, v10
    v_sub_f32 v231, v231, v10
    v_sub_f32 v232, v232, v10
    v_sub_f32 v233, v233, v10
    v_sub_f32 v234, v234, v10
    v_sub_f32 v235, v235, v10
    v_sub_f32 v236, v236, v10
    v_sub_f32 v237, v237, v10
    v_sub_f32 v238, v238, v10
    v_sub_f32 v239, v239, v10
    v_mul_f32 v248, v248, v9
    v_mul_f32 v249, v249, v9
    v_mul_f32 v250, v250, v9
    v_mul_f32 v251, v251, v9
    s_mov_b64 s[74:75], -1
    s_nop 1
L_noupd1:
    v_mfma_f32_32x32x16_bf16 v[80:95], v[212:215], v[136:139], v[80:95]
    ds_read_b64_tr_b16 v[200:201], v28 offset:8192
    ds_read_b64_tr_b16 v[202:203], v29 offset:10240
    v_exp_f32 v160, v160
    v_exp_f32 v161, v161
    s_waitcnt lgkmcnt(6)
    v_mfma_f32_32x32x16_bf16 v[96:111], v[216:219], v[136:139], v[96:111]
    ds_read_b64_tr_b16 v[204:205], v30 offset:8192
    ds_read_b64_tr_b16 v[206:207], v31 offset:10240
    v_exp_f32 v162, v162
    v_cvt_pk_bf16_f32 v160, v160, v161
    v_mfma_f32_32x32x16_bf16 v[112:127], v[220:223], v[136:139], v[112:127]
    ds_read_b64_tr_b16 v[208:209], v24 offset:12288
    ds_read_b64_tr_b16 v[210:211], v25 offset:14336
    v_exp_f32 v163, v163
    v_exp_f32 v164, v164
    s_waitcnt lgkmcnt(6)
    v_mfma_f32_32x32x16_bf16 v[64:79], v[192:195], v[144:147], v[64:79]
    ds_read_b64_tr_b16 v[212:213], v26 offset:12288
    ds_read_b64_tr_b16 v[214:215], v27 offset:14336
    v_cvt_pk_bf16_f32 v161, v162, v163
    v_exp_f32 v165, v165
    v_exp_f32 v166, v166
    v_mfma_f32_32x32x16_bf16 v[80:95], v[196:199], v[144:147], v[80:95]
    ds_read_b64_tr_b16 v[216:217], v28 offset:12288
    ds_read_b64_tr_b16 v[218:219], v29 offset:14336
    v_cvt_pk_bf16_f32 v162, v164, v165
    v_exp_f32 v167, v167
    s_waitcnt lgkmcnt(6)
    v_mfma_f32_32x32x16_bf16 v[96:111], v[200:203], v[144:147], v[96:111]
    ds_read_b64_tr_b16 v[220:221], v30 offset:12288
    ds_read_b64_tr_b16 v[222:223], v31 offset:14336
    v_dot2_f32_bf16 v248, v160, s69, v248
    v_cvt_pk_bf16_f32 v163, v166, v167
    v_dot2_f32_bf16 v249, v161, s69, v249
    v_mfma_f32_32x32x16_bf16 v[112:127], v[204:207], v[144:147], v[112:127]
    ds_read_b128 v[192:195], v16 offset:32768
    v_dot2_f32_bf16 v250, v162, s69, v250
    v_dot2_f32_bf16 v251, v163, s69, v251
    v_exp_f32 v168, v168
    s_waitcnt lgkmcnt(5)
    v_mfma_f32_32x32x16_bf16 v[64:79], v[208:211], v[152:155], v[64:79]
    ds_read_b128 v[196:199], v17 offset:32768
    v_exp_f32 v169, v169
    v_exp_f32 v170, v170
    v_mfma_f32_32x32x16_bf16 v[80:95], v[212:215], v[152:155], v[80:95]
    ds_read_b128 v[200:203], v18 offset:32768
    v_cvt_pk_bf16_f32 v168, v168, v169
    v_exp_f32 v171, v171
    s_waitcnt lgkmcnt(3)
    v_mfma_f32_32x32x16_bf16 v[96:111], v[216:219], v[152:155], v[96:111]
    ds_read_b128 v[204:207], v19 offset:32768
    v_exp_f32 v172, v172
    v_cvt_pk_bf16_f32 v169, v170, v171
    v_exp_f32 v173, v173
    v_mfma_f32_32x32x16_bf16 v[112:127], v[220:223], v[152:155], v[112:127]
    ds_read_b128 v[208:211], v20 offset:32768
    v_exp_f32 v174, v174
    v_cvt_pk_bf16_f32 v170, v172, v173
    s_waitcnt lgkmcnt(3)
    v_mfma_f32_32x32x16_bf16 v[128:143], v[192:195], v[32:35], v[224:239]
    ds_read_b128 v[212:215], v21 offset:32768
    v_exp_f32 v175, v175
    v_dot2_f32_bf16 v248, v168, s69, v248
    v_cvt_pk_bf16_f32 v171, v174, v175
    v_mfma_f32_32x32x16_bf16 v[128:143], v[196:199], v[36:39], v[128:143]
    ds_read_b128 v[216:219], v22 offset:32768
    v_dot2_f32_bf16 v249, v169, s69, v249
    v_dot2_f32_bf16 v250, v170, s69, v250
    v_dot2_f32_bf16 v251, v171, s69, v251
    s_waitcnt lgkmcnt(3)
    v_mfma_f32_32x32x16_bf16 v[128:143], v[200:203], v[40:43], v[128:143]
    ds_read_b128 v[220:223], v23 offset:32768
    v_exp_f32 v176, v176
    v_exp_f32 v177, v177
    v_mfma_f32_32x32x16_bf16 v[128:143], v[204:207], v[44:47], v[128:143]
    ds_read_b128 v[192:195], v16 offset:40960
    v_exp_f32 v178, v178
    v_cvt_pk_bf16_f32 v176, v176, v177
    s_waitcnt lgkmcnt(3)
    v_mfma_f32_32x32x16_bf16 v[128:143], v[208:211], v[48:51], v[128:143]
    ds_read_b128 v[196:199], v17 offset:40960
    v_exp_f32 v179, v179
    v_exp_f32 v180, v180
    v_mfma_f32_32x32x16_bf16 v[128:143], v[212:215], v[52:55], v[128:143]
    ds_read_b128 v[200:203], v18 offset:40960
    v_cvt_pk_bf16_f32 v177, v178, v179
    v_exp_f32 v181, v181
    s_waitcnt lgkmcnt(3)
    v_mfma_f32_32x32x16_bf16 v[128:143], v[216:219], v[56:59], v[128:143]
    ds_read_b128 v[204:207], v19 offset:40960
    v_exp_f32 v182, v182
    v_cvt_pk_bf16_f32 v178, v180, v181
    v_exp_f32 v183, v183
    v_mfma_f32_32x32x16_bf16 v[128:143], v[220:223], v[60:63], v[128:143]
    ds_read_b128 v[208:211], v20 offset:40960
    v_dot2_f32_bf16 v248, v176, s69, v248
    v_cvt_pk_bf16_f32 v179, v182, v183
    v_dot2_f32_bf16 v249, v177, s69, v249
    s_waitcnt lgkmcnt(3)
    v_mfma_f32_32x32x16_bf16 v[144:159], v[192:195], v[32:35], v[224:239]
    ds_read_b128 v[212:215], v21 offset:40960
    v_dot2_f32_bf16 v250, v178, s69, v250
    v_dot2_f32_bf16 v251, v179, s69, v251
    v_exp_f32 v184, v184
    v_mfma_f32_32x32x16_bf16 v[144:159], v[196:199], v[36:39], v[144:159]
    ds_read_b128 v[216:219], v22 offset:40960
    v_exp_f32 v185, v185
    v_exp_f32 v186, v186
    s_waitcnt lgkmcnt(3)
    v_mfma_f32_32x32x16_bf16 v[144:159], v[200:203], v[40:43], v[144:159]
    ds_read_b128 v[220:223], v23 offset:40960
    v_cvt_pk_bf16_f32 v184, v184, v185
    v_exp_f32 v187, v187
    v_mfma_f32_32x32x16_bf16 v[144:159], v[204:207], v[44:47], v[144:159]
    ds_read_b64_tr_b16 v[192:193], v24 offset:16384
    ds_read_b64_tr_b16 v[194:195], v25 offset:18432
    v_exp_f32 v188, v188
    v_cvt_pk_bf16_f32 v185, v186, v187
    s_waitcnt lgkmcnt(4)
    v_mfma_f32_32x32x16_bf16 v[144:159], v[208:211], v[48:51], v[144:159]
    ds_read_b64_tr_b16 v[196:197], v26 offset:16384
    ds_read_b64_tr_b16 v[198:199], v27 offset:18432
    v_exp_f32 v189, v189
    v_exp_f32 v190, v190
    v_cvt_pk_bf16_f32 v186, v188, v189
    v_mfma_f32_32x32x16_bf16 v[144:159], v[212:215], v[52:55], v[144:159]
    ds_read_b64_tr_b16 v[200:201], v28 offset:16384
    ds_read_b64_tr_b16 v[202:203], v29 offset:18432
    v_exp_f32 v191, v191
    v_dot2_f32_bf16 v248, v184, s69, v248
    s_waitcnt lgkmcnt(6)
    v_mfma_f32_32x32x16_bf16 v[144:159], v[216:219], v[56:59], v[144:159]
    ds_read_b64_tr_b16 v[204:205], v30 offset:16384
    ds_read_b64_tr_b16 v[206:207], v31 offset:18432
    v_cvt_pk_bf16_f32 v187, v190, v191
    v_dot2_f32_bf16 v249, v185, s69, v249
    v_dot2_f32_bf16 v250, v186, s69, v250
    v_dot2_f32_bf16 v251, v187, s69, v251
    v_mfma_f32_32x32x16_bf16 v[144:159], v[220:223], v[60:63], v[144:159]
    ds_read_b64_tr_b16 v[208:209], v24 offset:20480
    ds_read_b64_tr_b16 v[210:211], v25 offset:22528
    s_cmp_lg_u64 s[74:75], 0
    s_cbranch_scc0 L_noresc1
    v_mul_f32 v64, v64, v9
    v_mul_f32 v65, v65, v9
    v_mul_f32 v66, v66, v9
    v_mul_f32 v67, v67, v9
    v_mul_f32 v68, v68, v9
    v_mul_f32 v69, v69, v9
    v_mul_f32 v70, v70, v9
    v_mul_f32 v71, v71, v9
    v_mul_f32 v72, v72, v9
    v_mul_f32 v73, v73, v9
    v_mul_f32 v74, v74, v9
    v_mul_f32 v75, v75, v9
    v_mul_f32 v76, v76, v9
    v_mul_f32 v77, v77, v9
    v_mul_f32 v78, v78, v9
    v_mul_f32 v79, v79, v9
    v_mul_f32 v80, v80, v9
    v_mul_f32 v81, v81, v9
    v_mul_f32 v82, v82, v9
    v_mul_f32 v83, v83, v9
    v_mul_f32 v84, v84, v9
    v_mul_f32 v85, v85, v9
    v_mul_f32 v86, v86, v9
    v_mul_f32 v87, v87, v9
    v_mul_f32 v88, v88, v9
    v_mul_f32 v89, v89, v9
    v_mul_f32 v90, v90, v9
    v_mul_f32 v91, v91, v9
    v_mul_f32 v92, v92, v9
    v_mul_f32 v93, v93, v9
    v_mul_f32 v94, v94, v9
    v_mul_f32 v95, v95, v9
    v_mul_f32 v96, v96, v9
    v_mul_f32 v97, v97, v9
    v_mul_f32 v98, v98, v9
    v_mul_f32 v99, v99, v9
    v_mul_f32 v100, v100, v9
    v_mul_f32 v101, v101, v9
    v_mul_f32 v102, v102, v9
    v_mul_f32 v103, v103, v9
    v_mul_f32 v104, v104, v9
    v_mul_f32 v105, v105, v9
    v_mul_f32 v106, v106, v9
    v_mul_f32 v107, v107, v9
    v_mul_f32 v108, v108, v9
    v_mul_f32 v109, v109, v9
    v_mul_f32 v110, v110, v9
    v_mul_f32 v111, v111, v9
    v_mul_f32 v112, v112, v9
    v_mul_f32 v113, v113, v9
    v_mul_f32 v114, v114, v9
    v_mul_f32 v115, v115, v9
    v_mul_f32 v116, v116, v9
    v_mul_f32 v117, v117, v9
    v_mul_f32 v118, v118, v9
    v_mul_f32 v119, v119, v9
    v_mul_f32 v120, v120, v9
    v_mul_f32 v121, v121, v9
    v_mul_f32 v122, v122, v9
    v_mul_f32 v123, v123, v9
    v_mul_f32 v124, v124, v9
    v_mul_f32 v125, v125, v9
    v_mul_f32 v126, v126, v9
    v_mul_f32 v127, v127, v9
    s_mov_b64 s[74:75], 0
    s_nop 1
L_noresc1:
    s_barrier
    s_waitcnt lgkmcnt(6)
    v_mfma_f32_32x32x16_bf16 v[64:79], v[192:195], v[160:163], v[64:79]
    ds_read_b64_tr_b16 v[212:213], v26 offset:20480
    ds_read_b64_tr_b16 v[214:215], v27 offset:22528
    v_max3_f32 v10, v128, v129, v130
    s_nop 1
    v_max3_f32 v15, v144, v145, v146
    v_max3_f32 v10, v10, v131, v132
    v_max3_f32 v15, v15, v147, v148
    v_mfma_f32_32x32x16_bf16 v[80:95], v[196:199], v[160:163], v[80:95]
    ds_read_b64_tr_b16 v[216:217], v28 offset:20480
    ds_read_b64_tr_b16 v[218:219], v29 offset:22528
    v_max3_f32 v10, v10, v133, v134
    v_max3_f32 v15, v15, v149, v150
    v_max3_f32 v10, v10, v135, v136
    s_waitcnt lgkmcnt(6)
    v_mfma_f32_32x32x16_bf16 v[96:111], v[200:203], v[160:163], v[96:111]
    ds_read_b64_tr_b16 v[220:221], v30 offset:20480
    ds_read_b64_tr_b16 v[222:223], v31 offset:22528
    v_max3_f32 v15, v15, v151, v152
    v_max3_f32 v10, v10, v137, v138
    v_max3_f32 v15, v15, v153, v154
    v_max3_f32 v10, v10, v139, v140
    v_mfma_f32_32x32x16_bf16 v[112:127], v[204:207], v[160:163], v[112:127]
    ds_read_b64_tr_b16 v[192:193], v24 offset:24576
    ds_read_b64_tr_b16 v[194:195], v25 offset:26624
    v_max3_f32 v15, v15, v155, v156
    v_max3_f32 v10, v10, v141, v142
    v_max3_f32 v15, v15, v157, v158
    v_max3_f32 v10, v10, v143, v159
    s_waitcnt lgkmcnt(6)
    v_mfma_f32_32x32x16_bf16 v[64:79], v[208:211], v[168:171], v[64:79]
    ds_read_b64_tr_b16 v[196:197], v26 offset:24576
    ds_read_b64_tr_b16 v[198:199], v27 offset:26624
    v_max_f32 v10, v10, v15
    v_cmp_lt_f32 vcc, s59, v10
    s_cbranch_vccz L_noupd2
    s_nop 2
    v_mov_b32 v15, v10
    s_nop 1
    v_permlane32_swap_b32 v10, v15
    v_max_f32 v10, v10, v15
    v_cmp_lt_f32 vcc, s59, v10
    s_nop 1
    v_cndmask_b32 v10, 0, v10, vcc
    v_exp_f32 v9, -v10
    v_sub_f32 v128, v128, v10
    v_sub_f32 v129, v129, v10
    v_sub_f32 v130, v130, v10
    v_sub_f32 v131, v131, v10
    v_sub_f32 v132, v132, v10
    v_sub_f32 v133, v133, v10
    v_sub_f32 v134, v134, v10
    v_sub_f32 v135, v135, v10
    v_sub_f32 v136, v136, v10
    v_sub_f32 v137, v137, v10
    v_sub_f32 v138, v138, v10
    v_sub_f32 v139, v139, v10
    v_sub_f32 v140, v140, v10
    v_sub_f32 v141, v141, v10
    v_sub_f32 v142, v142, v10
    v_sub_f32 v143, v143, v10
    v_sub_f32 v144, v144, v10
    v_sub_f32 v145, v145, v10
    v_sub_f32 v146, v146, v10
    v_sub_f32 v147, v147, v10
    v_sub_f32 v148, v148, v10
    v_sub_f32 v149, v149, v10
    v_sub_f32 v150, v150, v10
    v_sub_f32 v151, v151, v10
    v_sub_f32 v152, v152, v10
    v_sub_f32 v153, v153, v10
    v_sub_f32 v154, v154, v10
    v_sub_f32 v155, v155, v10
    v_sub_f32 v156, v156, v10
    v_sub_f32 v157, v157, v10
    v_sub_f32 v158, v158, v10
    v_sub_f32 v159, v159, v10
    v_sub_f32 v224, v224, v10
    v_sub_f32 v225, v225, v10
    v_sub_f32 v226, v226, v10
    v_sub_f32 v227, v227, v10
    v_sub_f32 v228, v228, v10
    v_sub_f32 v229, v229, v10
    v_sub_f32 v230, v230, v10
    v_sub_f32 v231, v231, v10
    v_sub_f32 v232, v232, v10
    v_sub_f32 v233, v233, v10
    v_sub_f32 v234, v234, v10
    v_sub_f32 v235, v235, v10
    v_sub_f32 v236, v236, v10
    v_sub_f32 v237, v237, v10
    v_sub_f32 v238, v238, v10
    v_sub_f32 v239, v239, v10
    v_mul_f32 v248, v248, v9
    v_mul_f32 v249, v249, v9
    v_mul_f32 v250, v250, v9
    v_mul_f32 v251, v251, v9
    s_mov_b64 s[74:75], -1
    s_nop 1
L_noupd2:
    v_mfma_f32_32x32x16_bf16 v[80:95], v[212:215], v[168:171], v[80:95]
    ds_read_b64_tr_b16 v[200:201], v28 offset:24576
    ds_read_b64_tr_b16 v[202:203], v29 offset:26624
    v_exp_f32 v128, v128
    v_exp_f32 v129, v129
    s_waitcnt lgkmcnt(6)
    v_mfma_f32_32x32x16_bf16 v[96:111], v[216:219], v[168:171], v[96:111]
    ds_read_b64_tr_b16 v[204:205], v30 offset:24576
    ds_read_b64_tr_b16 v[206:207], v31 offset:26624
    v_exp_f32 v130, v130
    v_cvt_pk_bf16_f32 v128, v128, v129
    v_mfma_f32_32x32x16_bf16 v[112:127], v[220:223], v[168:171], v[112:127]
    ds_read_b64_tr_b16 v[208:209], v24 offset:28672
    ds_read_b64_tr_b16 v[210:211], v25 offset:30720
    v_exp_f32 v131, v131
    v_exp_f32 v132, v132
    s_waitcnt lgkmcnt(6)
    v_mfma_f32_32x32x16_bf16 v[64:79], v[192:195], v[176:179], v[64:79]
    ds_read_b64_tr_b16 v[212:213], v26 offset:28672
    ds_read_b64_tr_b16 v[214:215], v27 offset:30720
    v_cvt_pk_bf16_f32 v129, v130, v131
    v_exp_f32 v133, v133
    v_exp_f32 v134, v134
    v_mfma_f32_32x32x16_bf16 v[80:95], v[196:199], v[176:179], v[80:95]
    ds_read_b64_tr_b16 v[216:217], v28 offset:28672
    ds_read_b64_tr_b16 v[218:219], v29 offset:30720
    v_cvt_pk_bf16_f32 v130, v132, v133
    v_exp_f32 v135, v135
    s_waitcnt lgkmcnt(6)
    v_mfma_f32_32x32x16_bf16 v[96:111], v[200:203], v[176:179], v[96:111]
    ds_read_b64_tr_b16 v[220:221], v30 offset:28672
    ds_read_b64_tr_b16 v[222:223], v31 offset:30720
    v_dot2_f32_bf16 v248, v128, s69, v248
    v_cvt_pk_bf16_f32 v131, v134, v135
    v_dot2_f32_bf16 v249, v129, s69, v249
    v_mfma_f32_32x32x16_bf16 v[112:127], v[204:207], v[176:179], v[112:127]
    ds_read_b128 v[192:195], v16 offset:49152
    v_dot2_f32_bf16 v250, v130, s69, v250
    v_dot2_f32_bf16 v251, v131, s69, v251
    v_exp_f32 v136, v136
    s_waitcnt lgkmcnt(5)
    v_mfma_f32_32x32x16_bf16 v[64:79], v[208:211], v[184:187], v[64:79]
    ds_read_b128 v[196:199], v17 offset:49152
    v_exp_f32 v137, v137
    v_exp_f32 v138, v138
    v_mfma_f32_32x32x16_bf16 v[80:95], v[212:215], v[184:187], v[80:95]
    ds_read_b128 v[200:203], v18 offset:49152
    v_cvt_pk_bf16_f32 v136, v136, v137
    v_exp_f32 v139, v139
    s_waitcnt lgkmcnt(3)
    v_mfma_f32_32x32x16_bf16 v[96:111], v[216:219], v[184:187], v[96:111]
    ds_read_b128 v[204:207], v19 offset:49152
    v_exp_f32 v140, v140
    v_cvt_pk_bf16_f32 v137, v138, v139
    v_exp_f32 v141, v141
    v_mfma_f32_32x32x16_bf16 v[112:127], v[220:223], v[184:187], v[112:127]
    ds_read_b128 v[208:211], v20 offset:49152
    v_exp_f32 v142, v142
    v_cvt_pk_bf16_f32 v138, v140, v141
    s_waitcnt lgkmcnt(3)
    v_mfma_f32_32x32x16_bf16 v[160:175], v[192:195], v[32:35], v[224:239]
    ds_read_b128 v[212:215], v21 offset:49152
    v_exp_f32 v143, v143
    v_dot2_f32_bf16 v248, v136, s69, v248
    v_cvt_pk_bf16_f32 v139, v142, v143
    v_mfma_f32_32x32x16_bf16 v[160:175], v[196:199], v[36:39], v[160:175]
    ds_read_b128 v[216:219], v22 offset:49152
    v_dot2_f32_bf16 v249, v137, s69, v249
    v_dot2_f32_bf16 v250, v138, s69, v250
    v_dot2_f32_bf16 v251, v139, s69, v251
    s_waitcnt lgkmcnt(3)
    v_mfma_f32_32x32x16_bf16 v[160:175], v[200:203], v[40:43], v[160:175]
    ds_read_b128 v[220:223], v23 offset:49152
    v_exp_f32 v144, v144
    v_exp_f32 v145, v145
    v_mfma_f32_32x32x16_bf16 v[160:175], v[204:207], v[44:47], v[160:175]
    ds_read_b128 v[192:195], v16 offset:57344
    v_exp_f32 v146, v146
    v_cvt_pk_bf16_f32 v144, v144, v145
    s_waitcnt lgkmcnt(3)
    v_mfma_f32_32x32x16_bf16 v[160:175], v[208:211], v[48:51], v[160:175]
    ds_read_b128 v[196:199], v17 offset:57344
    v_exp_f32 v147, v147
    v_exp_f32 v148, v148
    v_mfma_f32_32x32x16_bf16 v[160:175], v[212:215], v[52:55], v[160:175]
    ds_read_b128 v[200:203], v18 offset:57344
    v_cvt_pk_bf16_f32 v145, v146, v147
    v_exp_f32 v149, v149
    s_waitcnt lgkmcnt(3)
    v_mfma_f32_32x32x16_bf16 v[160:175], v[216:219], v[56:59], v[160:175]
    ds_read_b128 v[204:207], v19 offset:57344
    v_exp_f32 v150, v150
    v_cvt_pk_bf16_f32 v146, v148, v149
    v_exp_f32 v151, v151
    v_mfma_f32_32x32x16_bf16 v[160:175], v[220:223], v[60:63], v[160:175]
    ds_read_b128 v[208:211], v20 offset:57344
    v_dot2_f32_bf16 v248, v144, s69, v248
    v_cvt_pk_bf16_f32 v147, v150, v151
    v_dot2_f32_bf16 v249, v145, s69, v249
    s_waitcnt lgkmcnt(3)
    v_mfma_f32_32x32x16_bf16 v[176:191], v[192:195], v[32:35], v[224:239]
    ds_read_b128 v[212:215], v21 offset:57344
    v_dot2_f32_bf16 v250, v146, s69, v250
    v_dot2_f32_bf16 v251, v147, s69, v251
    v_exp_f32 v152, v152
    v_mfma_f32_32x32x16_bf16 v[176:191], v[196:199], v[36:39], v[176:191]
    ds_read_b128 v[216:219], v22 offset:57344
    v_exp_f32 v153, v153
    v_exp_f32 v154, v154
    s_waitcnt lgkmcnt(3)
    v_mfma_f32_32x32x16_bf16 v[176:191], v[200:203], v[40:43], v[176:191]
    ds_read_b128 v[220:223], v23 offset:57344
    v_cvt_pk_bf16_f32 v152, v152, v153
    v_exp_f32 v155, v155
    v_mfma_f32_32x32x16_bf16 v[176:191], v[204:207], v[44:47], v[176:191]
    ds_read_b64_tr_b16 v[192:193], v24 offset:32768
    ds_read_b64_tr_b16 v[194:195], v25 offset:34816
    v_exp_f32 v156, v156
    v_cvt_pk_bf16_f32 v153, v154, v155
    s_waitcnt lgkmcnt(4)
    v_mfma_f32_32x32x16_bf16 v[176:191], v[208:211], v[48:51], v[176:191]
    ds_read_b64_tr_b16 v[196:197], v26 offset:32768
    ds_read_b64_tr_b16 v[198:199], v27 offset:34816
    v_exp_f32 v157, v157
    v_exp_f32 v158, v158
    v_cvt_pk_bf16_f32 v154, v156, v157
    v_mfma_f32_32x32x16_bf16 v[176:191], v[212:215], v[52:55], v[176:191]
    ds_read_b64_tr_b16 v[200:201], v28 offset:32768
    ds_read_b64_tr_b16 v[202:203], v29 offset:34816
    v_exp_f32 v159, v159
    v_dot2_f32_bf16 v248, v152, s69, v248
    s_waitcnt lgkmcnt(6)
    v_mfma_f32_32x32x16_bf16 v[176:191], v[216:219], v[56:59], v[176:191]
    ds_read_b64_tr_b16 v[204:205], v30 offset:32768
    ds_read_b64_tr_b16 v[206:207], v31 offset:34816
    v_cvt_pk_bf16_f32 v155, v158, v159
    v_dot2_f32_bf16 v249, v153, s69, v249
    v_dot2_f32_bf16 v250, v154, s69, v250
    v_dot2_f32_bf16 v251, v155, s69, v251
    v_mfma_f32_32x32x16_bf16 v[176:191], v[220:223], v[60:63], v[176:191]
    ds_read_b64_tr_b16 v[208:209], v24 offset:36864
    ds_read_b64_tr_b16 v[210:211], v25 offset:38912
    s_cmp_lg_u64 s[74:75], 0
    s_cbranch_scc0 L_noresc2
    v_mul_f32 v64, v64, v9
    v_mul_f32 v65, v65, v9
    v_mul_f32 v66, v66, v9
    v_mul_f32 v67, v67, v9
    v_mul_f32 v68, v68, v9
    v_mul_f32 v69, v69, v9
    v_mul_f32 v70, v70, v9
    v_mul_f32 v71, v71, v9
    v_mul_f32 v72, v72, v9
    v_mul_f32 v73, v73, v9
    v_mul_f32 v74, v74, v9
    v_mul_f32 v75, v75, v9
    v_mul_f32 v76, v76, v9
    v_mul_f32 v77, v77, v9
    v_mul_f32 v78, v78, v9
    v_mul_f32 v79, v79, v9
    v_mul_f32 v80, v80, v9
    v_mul_f32 v81, v81, v9
    v_mul_f32 v82, v82, v9
    v_mul_f32 v83, v83, v9
    v_mul_f32 v84, v84, v9
    v_mul_f32 v85, v85, v9
    v_mul_f32 v86, v86, v9
    v_mul_f32 v87, v87, v9
    v_mul_f32 v88, v88, v9
    v_mul_f32 v89, v89, v9
    v_mul_f32 v90, v90, v9
    v_mul_f32 v91, v91, v9
    v_mul_f32 v92, v92, v9
    v_mul_f32 v93, v93, v9
    v_mul_f32 v94, v94, v9
    v_mul_f32 v95, v95, v9
    v_mul_f32 v96, v96, v9
    v_mul_f32 v97, v97, v9
    v_mul_f32 v98, v98, v9
    v_mul_f32 v99, v99, v9
    v_mul_f32 v100, v100, v9
    v_mul_f32 v101, v101, v9
    v_mul_f32 v102, v102, v9
    v_mul_f32 v103, v103, v9
    v_mul_f32 v104, v104, v9
    v_mul_f32 v105, v105, v9
    v_mul_f32 v106, v106, v9
    v_mul_f32 v107, v107, v9
    v_mul_f32 v108, v108, v9
    v_mul_f32 v109, v109, v9
    v_mul_f32 v110, v110, v9
    v_mul_f32 v111, v111, v9
    v_mul_f32 v112, v112, v9
    v_mul_f32 v113, v113, v9
    v_mul_f32 v114, v114, v9
    v_mul_f32 v115, v115, v9
    v_mul_f32 v116, v116, v9
    v_mul_f32 v117, v117, v9
    v_mul_f32 v118, v118, v9
    v_mul_f32 v119, v119, v9
    v_mul_f32 v120, v120, v9
    v_mul_f32 v121, v121, v9
    v_mul_f32 v122, v122, v9
    v_mul_f32 v123, v123, v9
    v_mul_f32 v124, v124, v9
    v_mul_f32 v125, v125, v9
    v_mul_f32 v126, v126, v9
    v_mul_f32 v127, v127, v9
    s_mov_b64 s[74:75], 0
    s_nop 1
L_noresc2:
    s_barrier
    s_waitcnt lgkmcnt(6)
    v_mfma_f32_32x32x16_bf16 v[64:79], v[192:195], v[128:131], v[64:79]
    ds_read_b64_tr_b16 v[212:213], v26 offset:36864
    ds_read_b64_tr_b16 v[214:215], v27 offset:38912
    v_max3_f32 v10, v160, v161, v162
    s_nop 1
    v_max3_f32 v15, v176, v177, v178
    v_max3_f32 v10, v10, v163, v164
    v_max3_f32 v15, v15, v179, v180
    v_mfma_f32_32x32x16_bf16 v[80:95], v[196:199], v[128:131], v[80:95]
    ds_read_b64_tr_b16 v[216:217], v28 offset:36864
    ds_read_b64_tr_b16 v[218:219], v29 offset:38912
    v_max3_f32 v10, v10, v165, v166
    v_max3_f32 v15, v15, v181, v182
    v_max3_f32 v10, v10, v167, v168
    s_waitcnt lgkmcnt(6)
    v_mfma_f32_32x32x16_bf16 v[96:111], v[200:203], v[128:131], v[96:111]
    ds_read_b64_tr_b16 v[220:221], v30 offset:36864
    ds_read_b64_tr_b16 v[222:223], v31 offset:38912
    v_max3_f32 v15, v15, v183, v184
    v_max3_f32 v10, v10, v169, v170
    v_max3_f32 v15, v15, v185, v186
    v_max3_f32 v10, v10, v171, v172
    v_mfma_f32_32x32x16_bf16 v[112:127], v[204:207], v[128:131], v[112:127]
    ds_read_b64_tr_b16 v[192:193], v24 offset:40960
    ds_read_b64_tr_b16 v[194:195], v25 offset:43008
    v_max3_f32 v15, v15, v187, v188
    v_max3_f32 v10, v10, v173, v174
    v_max3_f32 v15, v15, v189, v190
    v_max3_f32 v10, v10, v175, v191
    s_waitcnt lgkmcnt(6)
    v_mfma_f32_32x32x16_bf16 v[64:79], v[208:211], v[136:139], v[64:79]
    ds_read_b64_tr_b16 v[196:197], v26 offset:40960
    ds_read_b64_tr_b16 v[198:199], v27 offset:43008
    v_max_f32 v10, v10, v15
    v_cmp_lt_f32 vcc, s59, v10
    s_cbranch_vccz L_noupd3
    s_nop 2
    v_mov_b32 v15, v10
    s_nop 1
    v_permlane32_swap_b32 v10, v15
    v_max_f32 v10, v10, v15
    v_cmp_lt_f32 vcc, s59, v10
    s_nop 1
    v_cndmask_b32 v10, 0, v10, vcc
    v_exp_f32 v9, -v10
    v_sub_f32 v160, v160, v10
    v_sub_f32 v161, v161, v10
    v_sub_f32 v162, v162, v10
    v_sub_f32 v163, v163, v10
    v_sub_f32 v164, v164, v10
    v_sub_f32 v165, v165, v10
    v_sub_f32 v166, v166, v10
    v_sub_f32 v167, v167, v10
    v_sub_f32 v168, v168, v10
    v_sub_f32 v169, v169, v10
    v_sub_f32 v170, v170, v10
    v_sub_f32 v171, v171, v10
    v_sub_f32 v172, v172, v10
    v_sub_f32 v173, v173, v10
    v_sub_f32 v174, v174, v10
    v_sub_f32 v175, v175, v10
    v_sub_f32 v176, v176, v10
    v_sub_f32 v177, v177, v10
    v_sub_f32 v178, v178, v10
    v_sub_f32 v179, v179, v10
    v_sub_f32 v180, v180, v10
    v_sub_f32 v181, v181, v10
    v_sub_f32 v182, v182, v10
    v_sub_f32 v183, v183, v10
    v_sub_f32 v184, v184, v10
    v_sub_f32 v185, v185, v10
    v_sub_f32 v186, v186, v10
    v_sub_f32 v187, v187, v10
    v_sub_f32 v188, v188, v10
    v_sub_f32 v189, v189, v10
    v_sub_f32 v190, v190, v10
    v_sub_f32 v191, v191, v10
    v_sub_f32 v224, v224, v10
    v_sub_f32 v225, v225, v10
    v_sub_f32 v226, v226, v10
    v_sub_f32 v227, v227, v10
    v_sub_f32 v228, v228, v10
    v_sub_f32 v229, v229, v10
    v_sub_f32 v230, v230, v10
    v_sub_f32 v231, v231, v10
    v_sub_f32 v232, v232, v10
    v_sub_f32 v233, v233, v10
    v_sub_f32 v234, v234, v10
    v_sub_f32 v235, v235, v10
    v_sub_f32 v236, v236, v10
    v_sub_f32 v237, v237, v10
    v_sub_f32 v238, v238, v10
    v_sub_f32 v239, v239, v10
    v_mul_f32 v248, v248, v9
    v_mul_f32 v249, v249, v9
    v_mul_f32 v250, v250, v9
    v_mul_f32 v251, v251, v9
    s_mov_b64 s[74:75], -1
    s_nop 1
L_noupd3:
    v_mfma_f32_32x32x16_bf16 v[80:95], v[212:215], v[136:139], v[80:95]
    ds_read_b64_tr_b16 v[200:201], v28 offset:40960
    ds_read_b64_tr_b16 v[202:203], v29 offset:43008
    v_exp_f32 v160, v160
    v_exp_f32 v161, v161
    s_waitcnt lgkmcnt(6)
    v_mfma_f32_32x32x16_bf16 v[96:111], v[216:219], v[136:139], v[96:111]
    ds_read_b64_tr_b16 v[204:205], v30 offset:40960
    ds_read_b64_tr_b16 v[206:207], v31 offset:43008
    v_exp_f32 v162, v162
    v_cvt_pk_bf16_f32 v160, v160, v161
    v_mfma_f32_32x32x16_bf16 v[112:127], v[220:223], v[136:139], v[112:127]
    ds_read_b64_tr_b16 v[208:209], v24 offset:45056
    ds_read_b64_tr_b16 v[210:211], v25 offset:47104
    v_exp_f32 v163, v163
    v_exp_f32 v164, v164
    s_waitcnt lgkmcnt(6)
    v_mfma_f32_32x32x16_bf16 v[64:79], v[192:195], v[144:147], v[64:79]
    ds_read_b64_tr_b16 v[212:213], v26 offset:45056
    ds_read_b64_tr_b16 v[214:215], v27 offset:47104
    v_cvt_pk_bf16_f32 v161, v162, v163
    v_exp_f32 v165, v165
    v_exp_f32 v166, v166
    v_mfma_f32_32x32x16_bf16 v[80:95], v[196:199], v[144:147], v[80:95]
    ds_read_b64_tr_b16 v[216:217], v28 offset:45056
    ds_read_b64_tr_b16 v[218:219], v29 offset:47104
    v_cvt_pk_bf16_f32 v162, v164, v165
    v_exp_f32 v167, v167
    s_waitcnt lgkmcnt(6)
    v_mfma_f32_32x32x16_bf16 v[96:111], v[200:203], v[144:147], v[96:111]
    ds_read_b64_tr_b16 v[220:221], v30 offset:45056
    ds_read_b64_tr_b16 v[222:223], v31 offset:47104
    v_dot2_f32_bf16 v248, v160, s69, v248
    v_cvt_pk_bf16_f32 v163, v166, v167
    v_dot2_f32_bf16 v249, v161, s69, v249
    v_mfma_f32_32x32x16_bf16 v[112:127], v[204:207], v[144:147], v[112:127]
    v_add_u32 v16, 0x20000, v16
    ds_read_b128 v[192:195], v16 offset:0
    v_dot2_f32_bf16 v250, v162, s69, v250
    v_dot2_f32_bf16 v251, v163, s69, v251
    v_exp_f32 v168, v168
    s_waitcnt lgkmcnt(5)
    v_mfma_f32_32x32x16_bf16 v[64:79], v[208:211], v[152:155], v[64:79]
    v_add_u32 v17, 0x20000, v17
    ds_read_b128 v[196:199], v17 offset:0
    v_exp_f32 v169, v169
    v_exp_f32 v170, v170
    v_mfma_f32_32x32x16_bf16 v[80:95], v[212:215], v[152:155], v[80:95]
    v_add_u32 v18, 0x20000, v18
    ds_read_b128 v[200:203], v18 offset:0
    v_cvt_pk_bf16_f32 v168, v168, v169
    v_exp_f32 v171, v171
    s_waitcnt lgkmcnt(3)
    v_mfma_f32_32x32x16_bf16 v[96:111], v[216:219], v[152:155], v[96:111]
    v_add_u32 v19, 0x20000, v19
    ds_read_b128 v[204:207], v19 offset:0
    v_exp_f32 v172, v172
    v_cvt_pk_bf16_f32 v169, v170, v171
    v_exp_f32 v173, v173
    v_mfma_f32_32x32x16_bf16 v[112:127], v[220:223], v[152:155], v[112:127]
    v_add_u32 v20, 0x20000, v20
    ds_read_b128 v[208:211], v20 offset:0
    v_exp_f32 v174, v174
    v_cvt_pk_bf16_f32 v170, v172, v173
    s_waitcnt lgkmcnt(3)
    v_mfma_f32_32x32x16_bf16 v[128:143], v[192:195], v[32:35], v[224:239]
    v_add_u32 v21, 0x20000, v21
    ds_read_b128 v[212:215], v21 offset:0
    v_exp_f32 v175, v175
    v_dot2_f32_bf16 v248, v168, s69, v248
    v_cvt_pk_bf16_f32 v171, v174, v175
    v_mfma_f32_32x32x16_bf16 v[128:143], v[196:199], v[36:39], v[128:143]
    v_add_u32 v22, 0x20000, v22
    ds_read_b128 v[216:219], v22 offset:0
    v_dot2_f32_bf16 v249, v169, s69, v249
    v_dot2_f32_bf16 v250, v170, s69, v250
    v_dot2_f32_bf16 v251, v171, s69, v251
    s_waitcnt lgkmcnt(3)
    v_mfma_f32_32x32x16_bf16 v[128:143], v[200:203], v[40:43], v[128:143]
    v_add_u32 v23, 0x20000, v23
    ds_read_b128 v[220:223], v23 offset:0
    v_exp_f32 v176, v176
    v_exp_f32 v177, v177
    v_mfma_f32_32x32x16_bf16 v[128:143], v[204:207], v[44:47], v[128:143]
    ds_read_b128 v[192:195], v16 offset:8192
    v_subrev_u32 v16, 0x20000, v16
    v_exp_f32 v178, v178
    v_cvt_pk_bf16_f32 v176, v176, v177
    s_waitcnt lgkmcnt(3)
    v_mfma_f32_32x32x16_bf16 v[128:143], v[208:211], v[48:51], v[128:143]
    ds_read_b128 v[196:199], v17 offset:8192
    v_subrev_u32 v17, 0x20000, v17
    v_exp_f32 v179, v179
    v_exp_f32 v180, v180
    v_mfma_f32_32x32x16_bf16 v[128:143], v[212:215], v[52:55], v[128:143]
    ds_read_b128 v[200:203], v18 offset:8192
    v_subrev_u32 v18, 0x20000, v18
    v_cvt_pk_bf16_f32 v177, v178, v179
    v_exp_f32 v181, v181
    s_waitcnt lgkmcnt(3)
    v_mfma_f32_32x32x16_bf16 v[128:143], v[216:219], v[56:59], v[128:143]
    ds_read_b128 v[204:207], v19 offset:8192
    v_subrev_u32 v19, 0x20000, v19
    v_exp_f32 v182, v182
    v_cvt_pk_bf16_f32 v178, v180, v181
    v_exp_f32 v183, v183
    v_mfma_f32_32x32x16_bf16 v[128:143], v[220:223], v[60:63], v[128:143]
    ds_read_b128 v[208:211], v20 offset:8192
    v_subrev_u32 v20, 0x20000, v20
    v_dot2_f32_bf16 v248, v176, s69, v248
    v_cvt_pk_bf16_f32 v179, v182, v183
    v_dot2_f32_bf16 v249, v177, s69, v249
    s_waitcnt lgkmcnt(3)
    v_mfma_f32_32x32x16_bf16 v[144:159], v[192:195], v[32:35], v[224:239]
    ds_read_b128 v[212:215], v21 offset:8192
    v_subrev_u32 v21, 0x20000, v21
    v_dot2_f32_bf16 v250, v178, s69, v250
    v_dot2_f32_bf16 v251, v179, s69, v251
    v_exp_f32 v184, v184
    v_mfma_f32_32x32x16_bf16 v[144:159], v[196:199], v[36:39], v[144:159]
    ds_read_b128 v[216:219], v22 offset:8192
    v_subrev_u32 v22, 0x20000, v22
    v_exp_f32 v185, v185
    v_exp_f32 v186, v186
    s_waitcnt lgkmcnt(3)
    v_mfma_f32_32x32x16_bf16 v[144:159], v[200:203], v[40:43], v[144:159]
    ds_read_b128 v[220:223], v23 offset:8192
    v_subrev_u32 v23, 0x20000, v23
    v_cvt_pk_bf16_f32 v184, v184, v185
    v_exp_f32 v187, v187
    v_mfma_f32_32x32x16_bf16 v[144:159], v[204:207], v[44:47], v[144:159]
    ds_read_b64_tr_b16 v[192:193], v24 offset:49152
    ds_read_b64_tr_b16 v[194:195], v25 offset:51200
    v_exp_f32 v188, v188
    v_cvt_pk_bf16_f32 v185, v186, v187
    s_waitcnt lgkmcnt(4)
    v_mfma_f32_32x32x16_bf16 v[144:159], v[208:211], v[48:51], v[144:159]
    ds_read_b64_tr_b16 v[196:197], v26 offset:49152
    ds_read_b64_tr_b16 v[198:199], v27 offset:51200
    v_exp_f32 v189, v189
    v_exp_f32 v190, v190
    v_cvt_pk_bf16_f32 v186, v188, v189
    v_mfma_f32_32x32x16_bf16 v[144:159], v[212:215], v[52:55], v[144:159]
    ds_read_b64_tr_b16 v[200:201], v28 offset:49152
    ds_read_b64_tr_b16 v[202:203], v29 offset:51200
    v_exp_f32 v191, v191
    v_dot2_f32_bf16 v248, v184, s69, v248
    s_waitcnt lgkmcnt(6)
    v_mfma_f32_32x32x16_bf16 v[144:159], v[216:219], v[56:59], v[144:159]
    ds_read_b64_tr_b16 v[204:205], v30 offset:49152
    ds_read_b64_tr_b16 v[206:207], v31 offset:51200
    v_cvt_pk_bf16_f32 v187, v190, v191
    v_dot2_f32_bf16 v249, v185, s69, v249
    v_dot2_f32_bf16 v250, v186, s69, v250
    v_dot2_f32_bf16 v251, v187, s69, v251
    v_mfma_f32_32x32x16_bf16 v[144:159], v[220:223], v[60:63], v[144:159]
    ds_read_b64_tr_b16 v[208:209], v24 offset:53248
    ds_read_b64_tr_b16 v[210:211], v25 offset:55296
    s_cmp_lg_u64 s[74:75], 0
    s_cbranch_scc0 L_noresc3
    v_mul_f32 v64, v64, v9
    v_mul_f32 v65, v65, v9
    v_mul_f32 v66, v66, v9
    v_mul_f32 v67, v67, v9
    v_mul_f32 v68, v68, v9
    v_mul_f32 v69, v69, v9
    v_mul_f32 v70, v70, v9
    v_mul_f32 v71, v71, v9
    v_mul_f32 v72, v72, v9
    v_mul_f32 v73, v73, v9
    v_mul_f32 v74, v74, v9
    v_mul_f32 v75, v75, v9
    v_mul_f32 v76, v76, v9
    v_mul_f32 v77, v77, v9
    v_mul_f32 v78, v78, v9
    v_mul_f32 v79, v79, v9
    v_mul_f32 v80, v80, v9
    v_mul_f32 v81, v81, v9
    v_mul_f32 v82, v82, v9
    v_mul_f32 v83, v83, v9
    v_mul_f32 v84, v84, v9
    v_mul_f32 v85, v85, v9
    v_mul_f32 v86, v86, v9
    v_mul_f32 v87, v87, v9
    v_mul_f32 v88, v88, v9
    v_mul_f32 v89, v89, v9
    v_mul_f32 v90, v90, v9
    v_mul_f32 v91, v91, v9
    v_mul_f32 v92, v92, v9
    v_mul_f32 v93, v93, v9
    v_mul_f32 v94, v94, v9
    v_mul_f32 v95, v95, v9
    v_mul_f32 v96, v96, v9
    v_mul_f32 v97, v97, v9
    v_mul_f32 v98, v98, v9
    v_mul_f32 v99, v99, v9
    v_mul_f32 v100, v100, v9
    v_mul_f32 v101, v101, v9
    v_mul_f32 v102, v102, v9
    v_mul_f32 v103, v103, v9
    v_mul_f32 v104, v104, v9
    v_mul_f32 v105, v105, v9
    v_mul_f32 v106, v106, v9
    v_mul_f32 v107, v107, v9
    v_mul_f32 v108, v108, v9
    v_mul_f32 v109, v109, v9
    v_mul_f32 v110, v110, v9
    v_mul_f32 v111, v111, v9
    v_mul_f32 v112, v112, v9
    v_mul_f32 v113, v113, v9
    v_mul_f32 v114, v114, v9
    v_mul_f32 v115, v115, v9
    v_mul_f32 v116, v116, v9
    v_mul_f32 v117, v117, v9
    v_mul_f32 v118, v118, v9
    v_mul_f32 v119, v119, v9
    v_mul_f32 v120, v120, v9
    v_mul_f32 v121, v121, v9
    v_mul_f32 v122, v122, v9
    v_mul_f32 v123, v123, v9
    v_mul_f32 v124, v124, v9
    v_mul_f32 v125, v125, v9
    v_mul_f32 v126, v126, v9
    v_mul_f32 v127, v127, v9
    s_mov_b64 s[74:75], 0
    s_nop 1
L_noresc3:
    s_barrier
    s_waitcnt lgkmcnt(6)
    v_mfma_f32_32x32x16_bf16 v[64:79], v[192:195], v[160:163], v[64:79]
    ds_read_b64_tr_b16 v[212:213], v26 offset:53248
    ds_read_b64_tr_b16 v[214:215], v27 offset:55296
    v_max3_f32 v10, v128, v129, v130
    s_nop 1
    v_max3_f32 v15, v144, v145, v146
    v_max3_f32 v10, v10, v131, v132
    v_max3_f32 v15, v15, v147, v148
    v_mfma_f32_32x32x16_bf16 v[80:95], v[196:199], v[160:163], v[80:95]
    ds_read_b64_tr_b16 v[216:217], v28 offset:53248
    ds_read_b64_tr_b16 v[218:219], v29 offset:55296
    v_max3_f32 v10, v10, v133, v134
    v_max3_f32 v15, v15, v149, v150
    v_max3_f32 v10, v10, v135, v136
    s_waitcnt lgkmcnt(6)
    v_mfma_f32_32x32x16_bf16 v[96:111], v[200:203], v[160:163], v[96:111]
    ds_read_b64_tr_b16 v[220:221], v30 offset:53248
    ds_read_b64_tr_b16 v[222:223], v31 offset:55296
    v_max3_f32 v15, v15, v151, v152
    v_max3_f32 v10, v10, v137, v138
    v_max3_f32 v15, v15, v153, v154
    v_max3_f32 v10, v10, v139, v140
    v_mfma_f32_32x32x16_bf16 v[112:127], v[204:207], v[160:163], v[112:127]
    ds_read_b64_tr_b16 v[192:193], v24 offset:57344
    ds_read_b64_tr_b16 v[194:195], v25 offset:59392
    v_max3_f32 v15, v15, v155, v156
    v_max3_f32 v10, v10, v141, v142
    v_max3_f32 v15, v15, v157, v158
    v_max3_f32 v10, v10, v143, v159
    s_waitcnt lgkmcnt(6)
    v_mfma_f32_32x32x16_bf16 v[64:79], v[208:211], v[168:171], v[64:79]
    ds_read_b64_tr_b16 v[196:197], v26 offset:57344
    ds_read_b64_tr_b16 v[198:199], v27 offset:59392
    v_max_f32 v10, v10, v15
    v_cmp_lt_f32 vcc, s59, v10
    s_cbranch_vccz L_noupd4
    s_nop 2
    v_mov_b32 v15, v10
    s_nop 1
    v_permlane32_swap_b32 v10, v15
    v_max_f32 v10, v10, v15
    v_cmp_lt_f32 vcc, s59, v10
    s_nop 1
    v_cndmask_b32 v10, 0, v10, vcc
    v_exp_f32 v9, -v10
    v_sub_f32 v128, v128, v10
    v_sub_f32 v129, v129, v10
    v_sub_f32 v130, v130, v10
    v_sub_f32 v131, v131, v10
    v_sub_f32 v132, v132, v10
    v_sub_f32 v133, v133, v10
    v_sub_f32 v134, v134, v10
    v_sub_f32 v135, v135, v10
    v_sub_f32 v136, v136, v10
    v_sub_f32 v137, v137, v10
    v_sub_f32 v138, v138, v10
    v_sub_f32 v139, v139, v10
    v_sub_f32 v140, v140, v10
    v_sub_f32 v141, v141, v10
    v_sub_f32 v142, v142, v10
    v_sub_f32 v143, v143, v10
    v_sub_f32 v144, v144, v10
    v_sub_f32 v145, v145, v10
    v_sub_f32 v146, v146, v10
    v_sub_f32 v147, v147, v10
    v_sub_f32 v148, v148, v10
    v_sub_f32 v149, v149, v10
    v_sub_f32 v150, v150, v10
    v_sub_f32 v151, v151, v10
    v_sub_f32 v152, v152, v10
    v_sub_f32 v153, v153, v10
    v_sub_f32 v154, v154, v10
    v_sub_f32 v155, v155, v10
    v_sub_f32 v156, v156, v10
    v_sub_f32 v157, v157, v10
    v_sub_f32 v158, v158, v10
    v_sub_f32 v159, v159, v10
    v_sub_f32 v224, v224, v10
    v_sub_f32 v225, v225, v10
    v_sub_f32 v226, v226, v10
    v_sub_f32 v227, v227, v10
    v_sub_f32 v228, v228, v10
    v_sub_f32 v229, v229, v10
    v_sub_f32 v230, v230, v10
    v_sub_f32 v231, v231, v10
    v_sub_f32 v232, v232, v10
    v_sub_f32 v233, v233, v10
    v_sub_f32 v234, v234, v10
    v_sub_f32 v235, v235, v10
    v_sub_f32 v236, v236, v10
    v_sub_f32 v237, v237, v10
    v_sub_f32 v238, v238, v10
    v_sub_f32 v239, v239, v10
    v_mul_f32 v248, v248, v9
    v_mul_f32 v249, v249, v9
    v_mul_f32 v250, v250, v9
    v_mul_f32 v251, v251, v9
    s_mov_b64 s[74:75], -1
    s_nop 1
L_noupd4:
    v_mfma_f32_32x32x16_bf16 v[80:95], v[212:215], v[168:171], v[80:95]
    ds_read_b64_tr_b16 v[200:201], v28 offset:57344
    ds_read_b64_tr_b16 v[202:203], v29 offset:59392
    v_exp_f32 v128, v128
    v_exp_f32 v129, v129
    s_waitcnt lgkmcnt(6)
    v_mfma_f32_32x32x16_bf16 v[96:111], v[216:219], v[168:171], v[96:111]
    ds_read_b64_tr_b16 v[204:205], v30 offset:57344
    ds_read_b64_tr_b16 v[206:207], v31 offset:59392
    v_exp_f32 v130, v130
    v_cvt_pk_bf16_f32 v128, v128, v129
    v_mfma_f32_32x32x16_bf16 v[112:127], v[220:223], v[168:171], v[112:127]
    ds_read_b64_tr_b16 v[208:209], v24 offset:61440
    ds_read_b64_tr_b16 v[210:211], v25 offset:63488
    v_exp_f32 v131, v131
    v_exp_f32 v132, v132
    s_waitcnt lgkmcnt(6)
    v_mfma_f32_32x32x16_bf16 v[64:79], v[192:195], v[176:179], v[64:79]
    ds_read_b64_tr_b16 v[212:213], v26 offset:61440
    ds_read_b64_tr_b16 v[214:215], v27 offset:63488
    v_cvt_pk_bf16_f32 v129, v130, v131
    v_exp_f32 v133, v133
    v_exp_f32 v134, v134
    v_mfma_f32_32x32x16_bf16 v[80:95], v[196:199], v[176:179], v[80:95]
    ds_read_b64_tr_b16 v[216:217], v28 offset:61440
    ds_read_b64_tr_b16 v[218:219], v29 offset:63488
    v_cvt_pk_bf16_f32 v130, v132, v133
    v_exp_f32 v135, v135
    s_waitcnt lgkmcnt(6)
    v_mfma_f32_32x32x16_bf16 v[96:111], v[200:203], v[176:179], v[96:111]
    ds_read_b64_tr_b16 v[220:221], v30 offset:61440
    ds_read_b64_tr_b16 v[222:223], v31 offset:63488
    v_dot2_f32_bf16 v248, v128, s69, v248
    v_cvt_pk_bf16_f32 v131, v134, v135
    v_dot2_f32_bf16 v249, v129, s69, v249
    v_mfma_f32_32x32x16_bf16 v[112:127], v[204:207], v[176:179], v[112:127]
    ds_read_b128 v[192:195], v16 offset:0
    v_dot2_f32_bf16 v250, v130, s69, v250
    v_dot2_f32_bf16 v251, v131, s69, v251
    v_exp_f32 v136, v136
    s_waitcnt lgkmcnt(5)
    v_mfma_f32_32x32x16_bf16 v[64:79], v[208:211], v[184:187], v[64:79]
    ds_read_b128 v[196:199], v17 offset:0
    v_exp_f32 v137, v137
    v_exp_f32 v138, v138
    v_mfma_f32_32x32x16_bf16 v[80:95], v[212:215], v[184:187], v[80:95]
    ds_read_b128 v[200:203], v18 offset:0
    v_cvt_pk_bf16_f32 v136, v136, v137
    v_exp_f32 v139, v139
    s_waitcnt lgkmcnt(3)
    v_mfma_f32_32x32x16_bf16 v[96:111], v[216:219], v[184:187], v[96:111]
    ds_read_b128 v[204:207], v19 offset:0
    v_exp_f32 v140, v140
    v_cvt_pk_bf16_f32 v137, v138, v139
    v_exp_f32 v141, v141
    v_mfma_f32_32x32x16_bf16 v[112:127], v[220:223], v[184:187], v[112:127]
    ds_read_b128 v[208:211], v20 offset:0
    v_exp_f32 v142, v142
    v_cvt_pk_bf16_f32 v138, v140, v141
    s_waitcnt lgkmcnt(3)
    v_mfma_f32_32x32x16_bf16 v[160:175], v[192:195], v[32:35], v[224:239]
    ds_read_b128 v[212:215], v21 offset:0
    v_exp_f32 v143, v143
    v_dot2_f32_bf16 v248, v136, s69, v248
    v_cvt_pk_bf16_f32 v139, v142, v143
    v_mfma_f32_32x32x16_bf16 v[160:175], v[196:199], v[36:39], v[160:175]
    ds_read_b128 v[216:219], v22 offset:0
    v_dot2_f32_bf16 v249, v137, s69, v249
    v_dot2_f32_bf16 v250, v138, s69, v250
    v_dot2_f32_bf16 v251, v139, s69, v251
    s_waitcnt lgkmcnt(3)
    v_mfma_f32_32x32x16_bf16 v[160:175], v[200:203], v[40:43], v[160:175]
    ds_read_b128 v[220:223], v23 offset:0
    v_exp_f32 v144, v144
    v_exp_f32 v145, v145
    v_mfma_f32_32x32x16_bf16 v[160:175], v[204:207], v[44:47], v[160:175]
    ds_read_b128 v[192:195], v16 offset:8192
    v_exp_f32 v146, v146
    v_cvt_pk_bf16_f32 v144, v144, v145
    s_waitcnt lgkmcnt(3)
    v_mfma_f32_32x32x16_bf16 v[160:175], v[208:211], v[48:51], v[160:175]
    ds_read_b128 v[196:199], v17 offset:8192
    v_exp_f32 v147, v147
    v_exp_f32 v148, v148
    v_mfma_f32_32x32x16_bf16 v[160:175], v[212:215], v[52:55], v[160:175]
    ds_read_b128 v[200:203], v18 offset:8192
    v_cvt_pk_bf16_f32 v145, v146, v147
    v_exp_f32 v149, v149
    s_waitcnt lgkmcnt(3)
    v_mfma_f32_32x32x16_bf16 v[160:175], v[216:219], v[56:59], v[160:175]
    ds_read_b128 v[204:207], v19 offset:8192
    v_exp_f32 v150, v150
    v_cvt_pk_bf16_f32 v146, v148, v149
    v_exp_f32 v151, v151
    v_mfma_f32_32x32x16_bf16 v[160:175], v[220:223], v[60:63], v[160:175]
    ds_read_b128 v[208:211], v20 offset:8192
    v_dot2_f32_bf16 v248, v144, s69, v248
    v_cvt_pk_bf16_f32 v147, v150, v151
    v_dot2_f32_bf16 v249, v145, s69, v249
    s_waitcnt lgkmcnt(3)
    v_mfma_f32_32x32x16_bf16 v[176:191], v[192:195], v[32:35], v[224:239]
    ds_read_b128 v[212:215], v21 offset:8192
    v_dot2_f32_bf16 v250, v146, s69, v250
    v_dot2_f32_bf16 v251, v147, s69, v251
    v_exp_f32 v152, v152
    v_mfma_f32_32x32x16_bf16 v[176:191], v[196:199], v[36:39], v[176:191]
    ds_read_b128 v[216:219], v22 offset:8192
    v_exp_f32 v153, v153
    v_exp_f32 v154, v154
    s_waitcnt lgkmcnt(3)
    v_mfma_f32_32x32x16_bf16 v[176:191], v[200:203], v[40:43], v[176:191]
    ds_read_b128 v[220:223], v23 offset:8192
    v_cvt_pk_bf16_f32 v152, v152, v153
    v_exp_f32 v155, v155
    v_mfma_f32_32x32x16_bf16 v[176:191], v[204:207], v[44:47], v[176:191]
    v_add_u32 v24, 0x14000, v24
    ds_read_b64_tr_b16 v[192:193], v24 offset:0
    v_add_u32 v25, 0x14000, v25
    ds_read_b64_tr_b16 v[194:195], v25 offset:2048
    v_exp_f32 v156, v156
    v_cvt_pk_bf16_f32 v153, v154, v155
    s_waitcnt lgkmcnt(4)
    v_mfma_f32_32x32x16_bf16 v[176:191], v[208:211], v[48:51], v[176:191]
    v_add_u32 v26, 0x14000, v26
    ds_read_b64_tr_b16 v[196:197], v26 offset:0
    v_add_u32 v27, 0x14000, v27
    ds_read_b64_tr_b16 v[198:199], v27 offset:2048
    v_exp_f32 v157, v157
    v_exp_f32 v158, v158
    v_cvt_pk_bf16_f32 v154, v156, v157
    v_mfma_f32_32x32x16_bf16 v[176:191], v[212:215], v[52:55], v[176:191]
    v_add_u32 v28, 0x14000, v28
    ds_read_b64_tr_b16 v[200:201], v28 offset:0
    v_add_u32 v29, 0x14000, v29
    ds_read_b64_tr_b16 v[202:203], v29 offset:2048
    v_exp_f32 v159, v159
    v_dot2_f32_bf16 v248, v152, s69, v248
    s_waitcnt lgkmcnt(6)
    v_mfma_f32_32x32x16_bf16 v[176:191], v[216:219], v[56:59], v[176:191]
    v_add_u32 v30, 0x14000, v30
    ds_read_b64_tr_b16 v[204:205], v30 offset:0
    v_add_u32 v31, 0x14000, v31
    ds_read_b64_tr_b16 v[206:207], v31 offset:2048
    v_cvt_pk_bf16_f32 v155, v158, v159
    v_dot2_f32_bf16 v249, v153, s69, v249
    v_dot2_f32_bf16 v250, v154, s69, v250
    v_dot2_f32_bf16 v251, v155, s69, v251
    v_mfma_f32_32x32x16_bf16 v[176:191], v[220:223], v[60:63], v[176:191]
    ds_read_b64_tr_b16 v[208:209], v24 offset:4096
    ds_read_b64_tr_b16 v[210:211], v25 offset:6144
    s_cmp_lg_u64 s[74:75], 0
    s_cbranch_scc0 L_noresc4
    v_mul_f32 v64, v64, v9
    v_mul_f32 v65, v65, v9
    v_mul_f32 v66, v66, v9
    v_mul_f32 v67, v67, v9
    v_mul_f32 v68, v68, v9
    v_mul_f32 v69, v69, v9
    v_mul_f32 v70, v70, v9
    v_mul_f32 v71, v71, v9
    v_mul_f32 v72, v72, v9
    v_mul_f32 v73, v73, v9
    v_mul_f32 v74, v74, v9
    v_mul_f32 v75, v75, v9
    v_mul_f32 v76, v76, v9
    v_mul_f32 v77, v77, v9
    v_mul_f32 v78, v78, v9
    v_mul_f32 v79, v79, v9
    v_mul_f32 v80, v80, v9
    v_mul_f32 v81, v81, v9
    v_mul_f32 v82, v82, v9
    v_mul_f32 v83, v83, v9
    v_mul_f32 v84, v84, v9
    v_mul_f32 v85, v85, v9
    v_mul_f32 v86, v86, v9
    v_mul_f32 v87, v87, v9
    v_mul_f32 v88, v88, v9
    v_mul_f32 v89, v89, v9
    v_mul_f32 v90, v90, v9
    v_mul_f32 v91, v91, v9
    v_mul_f32 v92, v92, v9
    v_mul_f32 v93, v93, v9
    v_mul_f32 v94, v94, v9
    v_mul_f32 v95, v95, v9
    v_mul_f32 v96, v96, v9
    v_mul_f32 v97, v97, v9
    v_mul_f32 v98, v98, v9
    v_mul_f32 v99, v99, v9
    v_mul_f32 v100, v100, v9
    v_mul_f32 v101, v101, v9
    v_mul_f32 v102, v102, v9
    v_mul_f32 v103, v103, v9
    v_mul_f32 v104, v104, v9
    v_mul_f32 v105, v105, v9
    v_mul_f32 v106, v106, v9
    v_mul_f32 v107, v107, v9
    v_mul_f32 v108, v108, v9
    v_mul_f32 v109, v109, v9
    v_mul_f32 v110, v110, v9
    v_mul_f32 v111, v111, v9
    v_mul_f32 v112, v112, v9
    v_mul_f32 v113, v113, v9
    v_mul_f32 v114, v114, v9
    v_mul_f32 v115, v115, v9
    v_mul_f32 v116, v116, v9
    v_mul_f32 v117, v117, v9
    v_mul_f32 v118, v118, v9
    v_mul_f32 v119, v119, v9
    v_mul_f32 v120, v120, v9
    v_mul_f32 v121, v121, v9
    v_mul_f32 v122, v122, v9
    v_mul_f32 v123, v123, v9
    v_mul_f32 v124, v124, v9
    v_mul_f32 v125, v125, v9
    v_mul_f32 v126, v126, v9
    v_mul_f32 v127, v127, v9
    s_mov_b64 s[74:75], 0
    s_nop 1
L_noresc4:
    s_barrier
    s_waitcnt lgkmcnt(6)
    v_mfma_f32_32x32x16_bf16 v[64:79], v[192:195], v[128:131], v[64:79]
    ds_read_b64_tr_b16 v[212:213], v26 offset:4096
    ds_read_b64_tr_b16 v[214:215], v27 offset:6144
    v_max3_f32 v10, v160, v161, v162
    s_nop 1
    v_max3_f32 v15, v176, v177, v178
    v_max3_f32 v10, v10, v163, v164
    v_max3_f32 v15, v15, v179, v180
    v_mfma_f32_32x32x16_bf16 v[80:95], v[196:199], v[128:131], v[80:95]
    ds_read_b64_tr_b16 v[216:217], v28 offset:4096
    ds_read_b64_tr_b16 v[218:219], v29 offset:6144
    v_max3_f32 v10, v10, v165, v166
    v_max3_f32 v15, v15, v181, v182
    v_max3_f32 v10, v10, v167, v168
    s_waitcnt lgkmcnt(6)
    v_mfma_f32_32x32x16_bf16 v[96:111], v[200:203], v[128:131], v[96:111]
    ds_read_b64_tr_b16 v[220:221], v30 offset:4096
    ds_read_b64_tr_b16 v[222:223], v31 offset:6144
    v_max3_f32 v15, v15, v183, v184
    v_max3_f32 v10, v10, v169, v170
    v_max3_f32 v15, v15, v185, v186
    v_max3_f32 v10, v10, v171, v172
    v_mfma_f32_32x32x16_bf16 v[112:127], v[204:207], v[128:131], v[112:127]
    ds_read_b64_tr_b16 v[192:193], v24 offset:8192
    ds_read_b64_tr_b16 v[194:195], v25 offset:10240
    v_max3_f32 v15, v15, v187, v188
    v_max3_f32 v10, v10, v173, v174
    v_max3_f32 v15, v15, v189, v190
    v_max3_f32 v10, v10, v175, v191
    s_waitcnt lgkmcnt(6)
    v_mfma_f32_32x32x16_bf16 v[64:79], v[208:211], v[136:139], v[64:79]
    ds_read_b64_tr_b16 v[196:197], v26 offset:8192
    ds_read_b64_tr_b16 v[198:199], v27 offset:10240
    v_max_f32 v10, v10, v15
    v_cmp_lt_f32 vcc, s59, v10
    s_cbranch_vccz L_noupd5
    s_nop 2
    v_mov_b32 v15, v10
    s_nop 1
    v_permlane32_swap_b32 v10, v15
    v_max_f32 v10, v10, v15
    v_cmp_lt_f32 vcc, s59, v10
    s_nop 1
    v_cndmask_b32 v10, 0, v10, vcc
    v_exp_f32 v9, -v10
    v_sub_f32 v160, v160, v10
    v_sub_f32 v161, v161, v10
    v_sub_f32 v162, v162, v10
    v_sub_f32 v163, v163, v10
    v_sub_f32 v164, v164, v10
    v_sub_f32 v165, v165, v10
    v_sub_f32 v166, v166, v10
    v_sub_f32 v167, v167, v10
    v_sub_f32 v168, v168, v10
    v_sub_f32 v169, v169, v10
    v_sub_f32 v170, v170, v10
    v_sub_f32 v171, v171, v10
    v_sub_f32 v172, v172, v10
    v_sub_f32 v173, v173, v10
    v_sub_f32 v174, v174, v10
    v_sub_f32 v175, v175, v10
    v_sub_f32 v176, v176, v10
    v_sub_f32 v177, v177, v10
    v_sub_f32 v178, v178, v10
    v_sub_f32 v179, v179, v10
    v_sub_f32 v180, v180, v10
    v_sub_f32 v181, v181, v10
    v_sub_f32 v182, v182, v10
    v_sub_f32 v183, v183, v10
    v_sub_f32 v184, v184, v10
    v_sub_f32 v185, v185, v10
    v_sub_f32 v186, v186, v10
    v_sub_f32 v187, v187, v10
    v_sub_f32 v188, v188, v10
    v_sub_f32 v189, v189, v10
    v_sub_f32 v190, v190, v10
    v_sub_f32 v191, v191, v10
    v_sub_f32 v224, v224, v10
    v_sub_f32 v225, v225, v10
    v_sub_f32 v226, v226, v10
    v_sub_f32 v227, v227, v10
    v_sub_f32 v228, v228, v10
    v_sub_f32 v229, v229, v10
    v_sub_f32 v230, v230, v10
    v_sub_f32 v231, v231, v10
    v_sub_f32 v232, v232, v10
    v_sub_f32 v233, v233, v10
    v_sub_f32 v234, v234, v10
    v_sub_f32 v235, v235, v10
    v_sub_f32 v236, v236, v10
    v_sub_f32 v237, v237, v10
    v_sub_f32 v238, v238, v10
    v_sub_f32 v239, v239, v10
    v_mul_f32 v248, v248, v9
    v_mul_f32 v249, v249, v9
    v_mul_f32 v250, v250, v9
    v_mul_f32 v251, v251, v9
    s_mov_b64 s[74:75], -1
    s_nop 1
L_noupd5:
    v_mfma_f32_32x32x16_bf16 v[80:95], v[212:215], v[136:139], v[80:95]
    ds_read_b64_tr_b16 v[200:201], v28 offset:8192
    ds_read_b64_tr_b16 v[202:203], v29 offset:10240
    v_exp_f32 v160, v160
    v_exp_f32 v161, v161
    s_waitcnt lgkmcnt(6)
    v_mfma_f32_32x32x16_bf16 v[96:111], v[216:219], v[136:139], v[96:111]
    ds_read_b64_tr_b16 v[204:205], v30 offset:8192
    ds_read_b64_tr_b16 v[206:207], v31 offset:10240
    v_exp_f32 v162, v162
    v_cvt_pk_bf16_f32 v160, v160, v161
    v_mfma_f32_32x32x16_bf16 v[112:127], v[220:223], v[136:139], v[112:127]
    ds_read_b64_tr_b16 v[208:209], v24 offset:12288
    v_subrev_u32 v24, 0x14000, v24
    ds_read_b64_tr_b16 v[210:211], v25 offset:14336
    v_subrev_u32 v25, 0x14000, v25
    v_exp_f32 v163, v163
    v_exp_f32 v164, v164
    s_waitcnt lgkmcnt(6)
    v_mfma_f32_32x32x16_bf16 v[64:79], v[192:195], v[144:147], v[64:79]
    ds_read_b64_tr_b16 v[212:213], v26 offset:12288
    v_subrev_u32 v26, 0x14000, v26
    ds_read_b64_tr_b16 v[214:215], v27 offset:14336
    v_subrev_u32 v27, 0x14000, v27
    v_cvt_pk_bf16_f32 v161, v162, v163
    v_exp_f32 v165, v165
    v_exp_f32 v166, v166
    v_mfma_f32_32x32x16_bf16 v[80:95], v[196:199], v[144:147], v[80:95]
    ds_read_b64_tr_b16 v[216:217], v28 offset:12288
    v_subrev_u32 v28, 0x14000, v28
    ds_read_b64_tr_b16 v[218:219], v29 offset:14336
    v_subrev_u32 v29, 0x14000, v29
    v_cvt_pk_bf16_f32 v162, v164, v165
    v_exp_f32 v167, v167
    s_waitcnt lgkmcnt(6)
    v_mfma_f32_32x32x16_bf16 v[96:111], v[200:203], v[144:147], v[96:111]
    ds_read_b64_tr_b16 v[220:221], v30 offset:12288
    v_subrev_u32 v30, 0x14000, v30
    ds_read_b64_tr_b16 v[222:223], v31 offset:14336
    v_subrev_u32 v31, 0x14000, v31
    v_dot2_f32_bf16 v248, v160, s69, v248
    v_cvt_pk_bf16_f32 v163, v166, v167
    v_dot2_f32_bf16 v249, v161, s69, v249
    v_mfma_f32_32x32x16_bf16 v[112:127], v[204:207], v[144:147], v[112:127]
    ds_read_b128 v[192:195], v16 offset:16384
    v_dot2_f32_bf16 v250, v162, s69, v250
    v_dot2_f32_bf16 v251, v163, s69, v251
    v_exp_f32 v168, v168
    s_waitcnt lgkmcnt(5)
    v_mfma_f32_32x32x16_bf16 v[64:79], v[208:211], v[152:155], v[64:79]
    ds_read_b128 v[196:199], v17 offset:16384
    v_exp_f32 v169, v169
    v_exp_f32 v170, v170
    v_mfma_f32_32x32x16_bf16 v[80:95], v[212:215], v[152:155], v[80:95]
    ds_read_b128 v[200:203], v18 offset:16384
    v_cvt_pk_bf16_f32 v168, v168, v169
    v_exp_f32 v171, v171
    s_waitcnt lgkmcnt(3)
    v_mfma_f32_32x32x16_bf16 v[96:111], v[216:219], v[152:155], v[96:111]
    ds_read_b128 v[204:207], v19 offset:16384
    v_exp_f32 v172, v172
    v_cvt_pk_bf16_f32 v169, v170, v171
    v_exp_f32 v173, v173
    v_mfma_f32_32x32x16_bf16 v[112:127], v[220:223], v[152:155], v[112:127]
    ds_read_b128 v[208:211], v20 offset:16384
    v_exp_f32 v174, v174
    v_cvt_pk_bf16_f32 v170, v172, v173
    s_waitcnt lgkmcnt(3)
    v_mfma_f32_32x32x16_bf16 v[128:143], v[192:195], v[32:35], v[224:239]
    ds_read_b128 v[212:215], v21 offset:16384
    v_exp_f32 v175, v175
    v_dot2_f32_bf16 v248, v168, s69, v248
    v_cvt_pk_bf16_f32 v171, v174, v175
    v_mfma_f32_32x32x16_bf16 v[128:143], v[196:199], v[36:39], v[128:143]
    ds_read_b128 v[216:219], v22 offset:16384
    v_dot2_f32_bf16 v249, v169, s69, v249
    v_dot2_f32_bf16 v250, v170, s69, v250
    v_dot2_f32_bf16 v251, v171, s69, v251
    s_waitcnt lgkmcnt(3)
    v_mfma_f32_32x32x16_bf16 v[128:143], v[200:203], v[40:43], v[128:143]
    ds_read_b128 v[220:223], v23 offset:16384
    v_exp_f32 v176, v176
    v_exp_f32 v177, v177
    v_mfma_f32_32x32x16_bf16 v[128:143], v[204:207], v[44:47], v[128:143]
    ds_read_b128 v[192:195], v16 offset:24576
    v_exp_f32 v178, v178
    v_cvt_pk_bf16_f32 v176, v176, v177
    s_waitcnt lgkmcnt(3)
    v_mfma_f32_32x32x16_bf16 v[128:143], v[208:211], v[48:51], v[128:143]
    ds_read_b128 v[196:199], v17 offset:24576
    v_exp_f32 v179, v179
    v_exp_f32 v180, v180
    v_mfma_f32_32x32x16_bf16 v[128:143], v[212:215], v[52:55], v[128:143]
    ds_read_b128 v[200:203], v18 offset:24576
    v_cvt_pk_bf16_f32 v177, v178, v179
    v_exp_f32 v181, v181
    s_waitcnt lgkmcnt(3)
    v_mfma_f32_32x32x16_bf16 v[128:143], v[216:219], v[56:59], v[128:143]
    ds_read_b128 v[204:207], v19 offset:24576
    v_exp_f32 v182, v182
    v_cvt_pk_bf16_f32 v178, v180, v181
    v_exp_f32 v183, v183
    v_mfma_f32_32x32x16_bf16 v[128:143], v[220:223], v[60:63], v[128:143]
    ds_read_b128 v[208:211], v20 offset:24576
    v_dot2_f32_bf16 v248, v176, s69, v248
    v_cvt_pk_bf16_f32 v179, v182, v183
    v_dot2_f32_bf16 v249, v177, s69, v249
    s_waitcnt lgkmcnt(3)
    v_mfma_f32_32x32x16_bf16 v[144:159], v[192:195], v[32:35], v[224:239]
    ds_read_b128 v[212:215], v21 offset:24576
    v_dot2_f32_bf16 v250, v178, s69, v250
    v_dot2_f32_bf16 v251, v179, s69, v251
    v_exp_f32 v184, v184
    v_mfma_f32_32x32x16_bf16 v[144:159], v[196:199], v[36:39], v[144:159]
    ds_read_b128 v[216:219], v22 offset:24576
    v_exp_f32 v185, v185
    v_exp_f32 v186, v186
    s_waitcnt lgkmcnt(3)
    v_mfma_f32_32x32x16_bf16 v[144:159], v[200:203], v[40:43], v[144:159]
    ds_read_b128 v[220:223], v23 offset:24576
    v_cvt_pk_bf16_f32 v184, v184, v185
    v_exp_f32 v187, v187
    v_mfma_f32_32x32x16_bf16 v[144:159], v[204:207], v[44:47], v[144:159]
    ds_read_b64_tr_b16 v[192:193], v24 offset:0
    ds_read_b64_tr_b16 v[194:195], v25 offset:2048
    v_exp_f32 v188, v188
    v_cvt_pk_bf16_f32 v185, v186, v187
    s_waitcnt lgkmcnt(4)
    v_mfma_f32_32x32x16_bf16 v[144:159], v[208:211], v[48:51], v[144:159]
    ds_read_b64_tr_b16 v[196:197], v26 offset:0
    ds_read_b64_tr_b16 v[198:199], v27 offset:2048
    v_exp_f32 v189, v189
    v_exp_f32 v190, v190
    v_cvt_pk_bf16_f32 v186, v188, v189
    v_mfma_f32_32x32x16_bf16 v[144:159], v[212:215], v[52:55], v[144:159]
    ds_read_b64_tr_b16 v[200:201], v28 offset:0
    ds_read_b64_tr_b16 v[202:203], v29 offset:2048
    v_exp_f32 v191, v191
    v_dot2_f32_bf16 v248, v184, s69, v248
    s_waitcnt lgkmcnt(6)
    v_mfma_f32_32x32x16_bf16 v[144:159], v[216:219], v[56:59], v[144:159]
    ds_read_b64_tr_b16 v[204:205], v30 offset:0
    ds_read_b64_tr_b16 v[206:207], v31 offset:2048
    v_cvt_pk_bf16_f32 v187, v190, v191
    v_dot2_f32_bf16 v249, v185, s69, v249
    v_dot2_f32_bf16 v250, v186, s69, v250
    v_dot2_f32_bf16 v251, v187, s69, v251
    v_mfma_f32_32x32x16_bf16 v[144:159], v[220:223], v[60:63], v[144:159]
    ds_read_b64_tr_b16 v[208:209], v24 offset:4096
    ds_read_b64_tr_b16 v[210:211], v25 offset:6144
    s_cmp_lg_u64 s[74:75], 0
    s_cbranch_scc0 L_noresc5
    v_mul_f32 v64, v64, v9
    v_mul_f32 v65, v65, v9
    v_mul_f32 v66, v66, v9
    v_mul_f32 v67, v67, v9
    v_mul_f32 v68, v68, v9
    v_mul_f32 v69, v69, v9
    v_mul_f32 v70, v70, v9
    v_mul_f32 v71, v71, v9
    v_mul_f32 v72, v72, v9
    v_mul_f32 v73, v73, v9
    v_mul_f32 v74, v74, v9
    v_mul_f32 v75, v75, v9
    v_mul_f32 v76, v76, v9
    v_mul_f32 v77, v77, v9
    v_mul_f32 v78, v78, v9
    v_mul_f32 v79, v79, v9
    v_mul_f32 v80, v80, v9
    v_mul_f32 v81, v81, v9
    v_mul_f32 v82, v82, v9
    v_mul_f32 v83, v83, v9
    v_mul_f32 v84, v84, v9
    v_mul_f32 v85, v85, v9
    v_mul_f32 v86, v86, v9
    v_mul_f32 v87, v87, v9
    v_mul_f32 v88, v88, v9
    v_mul_f32 v89, v89, v9
    v_mul_f32 v90, v90, v9
    v_mul_f32 v91, v91, v9
    v_mul_f32 v92, v92, v9
    v_mul_f32 v93, v93, v9
    v_mul_f32 v94, v94, v9
    v_mul_f32 v95, v95, v9
    v_mul_f32 v96, v96, v9
    v_mul_f32 v97, v97, v9
    v_mul_f32 v98, v98, v9
    v_mul_f32 v99, v99, v9
    v_mul_f32 v100, v100, v9
    v_mul_f32 v101, v101, v9
    v_mul_f32 v102, v102, v9
    v_mul_f32 v103, v103, v9
    v_mul_f32 v104, v104, v9
    v_mul_f32 v105, v105, v9
    v_mul_f32 v106, v106, v9
    v_mul_f32 v107, v107, v9
    v_mul_f32 v108, v108, v9
    v_mul_f32 v109, v109, v9
    v_mul_f32 v110, v110, v9
    v_mul_f32 v111, v111, v9
    v_mul_f32 v112, v112, v9
    v_mul_f32 v113, v113, v9
    v_mul_f32 v114, v114, v9
    v_mul_f32 v115, v115, v9
    v_mul_f32 v116, v116, v9
    v_mul_f32 v117, v117, v9
    v_mul_f32 v118, v118, v9
    v_mul_f32 v119, v119, v9
    v_mul_f32 v120, v120, v9
    v_mul_f32 v121, v121, v9
    v_mul_f32 v122, v122, v9
    v_mul_f32 v123, v123, v9
    v_mul_f32 v124, v124, v9
    v_mul_f32 v125, v125, v9
    v_mul_f32 v126, v126, v9
    v_mul_f32 v127, v127, v9
    s_mov_b64 s[74:75], 0
    s_nop 1
L_noresc5:
    s_barrier
    s_waitcnt lgkmcnt(6)
    v_mfma_f32_32x32x16_bf16 v[64:79], v[192:195], v[160:163], v[64:79]
    ds_read_b64_tr_b16 v[212:213], v26 offset:4096
    ds_read_b64_tr_b16 v[214:215], v27 offset:6144
    v_max3_f32 v10, v128, v129, v130
    s_nop 1
    v_max3_f32 v15, v144, v145, v146
    v_max3_f32 v10, v10, v131, v132
    v_max3_f32 v15, v15, v147, v148
    v_mfma_f32_32x32x16_bf16 v[80:95], v[196:199], v[160:163], v[80:95]
    ds_read_b64_tr_b16 v[216:217], v28 offset:4096
    ds_read_b64_tr_b16 v[218:219], v29 offset:6144
    v_max3_f32 v10, v10, v133, v134
    v_max3_f32 v15, v15, v149, v150
    v_max3_f32 v10, v10, v135, v136
    s_waitcnt lgkmcnt(6)
    v_mfma_f32_32x32x16_bf16 v[96:111], v[200:203], v[160:163], v[96:111]
    ds_read_b64_tr_b16 v[220:221], v30 offset:4096
    ds_read_b64_tr_b16 v[222:223], v31 offset:6144
    v_max3_f32 v15, v15, v151, v152
    v_max3_f32 v10, v10, v137, v138
    v_max3_f32 v15, v15, v153, v154
    v_max3_f32 v10, v10, v139, v140
    v_mfma_f32_32x32x16_bf16 v[112:127], v[204:207], v[160:163], v[112:127]
    ds_read_b64_tr_b16 v[192:193], v24 offset:8192
    ds_read_b64_tr_b16 v[194:195], v25 offset:10240
    v_max3_f32 v15, v15, v155, v156
    v_max3_f32 v10, v10, v141, v142
    v_max3_f32 v15, v15, v157, v158
    v_max3_f32 v10, v10, v143, v159
    s_waitcnt lgkmcnt(6)
    v_mfma_f32_32x32x16_bf16 v[64:79], v[208:211], v[168:171], v[64:79]
    ds_read_b64_tr_b16 v[196:197], v26 offset:8192
    ds_read_b64_tr_b16 v[198:199], v27 offset:10240
    v_max_f32 v10, v10, v15
    v_cmp_lt_f32 vcc, s59, v10
    s_cbranch_vccz L_noupd6
    s_nop 2
    v_mov_b32 v15, v10
    s_nop 1
    v_permlane32_swap_b32 v10, v15
    v_max_f32 v10, v10, v15
    v_cmp_lt_f32 vcc, s59, v10
    s_nop 1
    v_cndmask_b32 v10, 0, v10, vcc
    v_exp_f32 v9, -v10
    v_sub_f32 v128, v128, v10
    v_sub_f32 v129, v129, v10
    v_sub_f32 v130, v130, v10
    v_sub_f32 v131, v131, v10
    v_sub_f32 v132, v132, v10
    v_sub_f32 v133, v133, v10
    v_sub_f32 v134, v134, v10
    v_sub_f32 v135, v135, v10
    v_sub_f32 v136, v136, v10
    v_sub_f32 v137, v137, v10
    v_sub_f32 v138, v138, v10
    v_sub_f32 v139, v139, v10
    v_sub_f32 v140, v140, v10
    v_sub_f32 v141, v141, v10
    v_sub_f32 v142, v142, v10
    v_sub_f32 v143, v143, v10
    v_sub_f32 v144, v144, v10
    v_sub_f32 v145, v145, v10
    v_sub_f32 v146, v146, v10
    v_sub_f32 v147, v147, v10
    v_sub_f32 v148, v148, v10
    v_sub_f32 v149, v149, v10
    v_sub_f32 v150, v150, v10
    v_sub_f32 v151, v151, v10
    v_sub_f32 v152, v152, v10
    v_sub_f32 v153, v153, v10
    v_sub_f32 v154, v154, v10
    v_sub_f32 v155, v155, v10
    v_sub_f32 v156, v156, v10
    v_sub_f32 v157, v157, v10
    v_sub_f32 v158, v158, v10
    v_sub_f32 v159, v159, v10
    v_sub_f32 v224, v224, v10
    v_sub_f32 v225, v225, v10
    v_sub_f32 v226, v226, v10
    v_sub_f32 v227, v227, v10
    v_sub_f32 v228, v228, v10
    v_sub_f32 v229, v229, v10
    v_sub_f32 v230, v230, v10
    v_sub_f32 v231, v231, v10
    v_sub_f32 v232, v232, v10
    v_sub_f32 v233, v233, v10
    v_sub_f32 v234, v234, v10
    v_sub_f32 v235, v235, v10
    v_sub_f32 v236, v236, v10
    v_sub_f32 v237, v237, v10
    v_sub_f32 v238, v238, v10
    v_sub_f32 v239, v239, v10
    v_mul_f32 v248, v248, v9
    v_mul_f32 v249, v249, v9
    v_mul_f32 v250, v250, v9
    v_mul_f32 v251, v251, v9
    s_mov_b64 s[74:75], -1
    s_nop 1
L_noupd6:
    v_mfma_f32_32x32x16_bf16 v[80:95], v[212:215], v[168:171], v[80:95]
    ds_read_b64_tr_b16 v[200:201], v28 offset:8192
    ds_read_b64_tr_b16 v[202:203], v29 offset:10240
    v_exp_f32 v128, v128
    v_exp_f32 v129, v129
    s_waitcnt lgkmcnt(6)
    v_mfma_f32_32x32x16_bf16 v[96:111], v[216:219], v[168:171], v[96:111]
    ds_read_b64_tr_b16 v[204:205], v30 offset:8192
    ds_read_b64_tr_b16 v[206:207], v31 offset:10240
    v_exp_f32 v130, v130
    v_cvt_pk_bf16_f32 v128, v128, v129
    v_mfma_f32_32x32x16_bf16 v[112:127], v[220:223], v[168:171], v[112:127]
    ds_read_b64_tr_b16 v[208:209], v24 offset:12288
    ds_read_b64_tr_b16 v[210:211], v25 offset:14336
    v_exp_f32 v131, v131
    v_exp_f32 v132, v132
    s_waitcnt lgkmcnt(6)
    v_mfma_f32_32x32x16_bf16 v[64:79], v[192:195], v[176:179], v[64:79]
    ds_read_b64_tr_b16 v[212:213], v26 offset:12288
    ds_read_b64_tr_b16 v[214:215], v27 offset:14336
    v_cvt_pk_bf16_f32 v129, v130, v131
    v_exp_f32 v133, v133
    v_exp_f32 v134, v134
    v_mfma_f32_32x32x16_bf16 v[80:95], v[196:199], v[176:179], v[80:95]
    ds_read_b64_tr_b16 v[216:217], v28 offset:12288
    ds_read_b64_tr_b16 v[218:219], v29 offset:14336
    v_cvt_pk_bf16_f32 v130, v132, v133
    v_exp_f32 v135, v135
    s_waitcnt lgkmcnt(6)
    v_mfma_f32_32x32x16_bf16 v[96:111], v[200:203], v[176:179], v[96:111]
    ds_read_b64_tr_b16 v[220:221], v30 offset:12288
    ds_read_b64_tr_b16 v[222:223], v31 offset:14336
    v_dot2_f32_bf16 v248, v128, s69, v248
    v_cvt_pk_bf16_f32 v131, v134, v135
    v_dot2_f32_bf16 v249, v129, s69, v249
    v_mfma_f32_32x32x16_bf16 v[112:127], v[204:207], v[176:179], v[112:127]
    ds_read_b128 v[192:195], v16 offset:32768
    v_dot2_f32_bf16 v250, v130, s69, v250
    v_dot2_f32_bf16 v251, v131, s69, v251
    v_exp_f32 v136, v136
    s_waitcnt lgkmcnt(5)
    v_mfma_f32_32x32x16_bf16 v[64:79], v[208:211], v[184:187], v[64:79]
    ds_read_b128 v[196:199], v17 offset:32768
    v_exp_f32 v137, v137
    v_exp_f32 v138, v138
    v_mfma_f32_32x32x16_bf16 v[80:95], v[212:215], v[184:187], v[80:95]
    ds_read_b128 v[200:203], v18 offset:32768
    v_cvt_pk_bf16_f32 v136, v136, v137
    v_exp_f32 v139, v139
    s_waitcnt lgkmcnt(3)
    v_mfma_f32_32x32x16_bf16 v[96:111], v[216:219], v[184:187], v[96:111]
    ds_read_b128 v[204:207], v19 offset:32768
    v_exp_f32 v140, v140
    v_cvt_pk_bf16_f32 v137, v138, v139
    v_exp_f32 v141, v141
    v_mfma_f32_32x32x16_bf16 v[112:127], v[220:223], v[184:187], v[112:127]
    ds_read_b128 v[208:211], v20 offset:32768
    v_exp_f32 v142, v142
    v_cvt_pk_bf16_f32 v138, v140, v141
    s_waitcnt lgkmcnt(3)
    v_mfma_f32_32x32x16_bf16 v[160:175], v[192:195], v[32:35], v[224:239]
    ds_read_b128 v[212:215], v21 offset:32768
    v_exp_f32 v143, v143
    v_dot2_f32_bf16 v248, v136, s69, v248
    v_cvt_pk_bf16_f32 v139, v142, v143
    v_mfma_f32_32x32x16_bf16 v[160:175], v[196:199], v[36:39], v[160:175]
    ds_read_b128 v[216:219], v22 offset:32768
    v_dot2_f32_bf16 v249, v137, s69, v249
    v_dot2_f32_bf16 v250, v138, s69, v250
    v_dot2_f32_bf16 v251, v139, s69, v251
    s_waitcnt lgkmcnt(3)
    v_mfma_f32_32x32x16_bf16 v[160:175], v[200:203], v[40:43], v[160:175]
    ds_read_b128 v[220:223], v23 offset:32768
    v_exp_f32 v144, v144
    v_exp_f32 v145, v145
    v_mfma_f32_32x32x16_bf16 v[160:175], v[204:207], v[44:47], v[160:175]
    ds_read_b128 v[192:195], v16 offset:40960
    v_exp_f32 v146, v146
    v_cvt_pk_bf16_f32 v144, v144, v145
    s_waitcnt lgkmcnt(3)
    v_mfma_f32_32x32x16_bf16 v[160:175], v[208:211], v[48:51], v[160:175]
    ds_read_b128 v[196:199], v17 offset:40960
    v_exp_f32 v147, v147
    v_exp_f32 v148, v148
    v_mfma_f32_32x32x16_bf16 v[160:175], v[212:215], v[52:55], v[160:175]
    ds_read_b128 v[200:203], v18 offset:40960
    v_cvt_pk_bf16_f32 v145, v146, v147
    v_exp_f32 v149, v149
    s_waitcnt lgkmcnt(3)
    v_mfma_f32_32x32x16_bf16 v[160:175], v[216:219], v[56:59], v[160:175]
    ds_read_b128 v[204:207], v19 offset:40960
    v_exp_f32 v150, v150
    v_cvt_pk_bf16_f32 v146, v148, v149
    v_exp_f32 v151, v151
    v_mfma_f32_32x32x16_bf16 v[160:175], v[220:223], v[60:63], v[160:175]
    ds_read_b128 v[208:211], v20 offset:40960
    v_dot2_f32_bf16 v248, v144, s69, v248
    v_cvt_pk_bf16_f32 v147, v150, v151
    v_dot2_f32_bf16 v249, v145, s69, v249
    s_waitcnt lgkmcnt(3)
    v_mfma_f32_32x32x16_bf16 v[176:191], v[192:195], v[32:35], v[224:239]
    ds_read_b128 v[212:215], v21 offset:40960
    v_dot2_f32_bf16 v250, v146, s69, v250
    v_dot2_f32_bf16 v251, v147, s69, v251
    v_exp_f32 v152, v152
    v_mfma_f32_32x32x16_bf16 v[176:191], v[196:199], v[36:39], v[176:191]
    ds_read_b128 v[216:219], v22 offset:40960
    v_exp_f32 v153, v153
    v_exp_f32 v154, v154
    s_waitcnt lgkmcnt(3)
    v_mfma_f32_32x32x16_bf16 v[176:191], v[200:203], v[40:43], v[176:191]
    ds_read_b128 v[220:223], v23 offset:40960
    v_cvt_pk_bf16_f32 v152, v152, v153
    v_exp_f32 v155, v155
    v_mfma_f32_32x32x16_bf16 v[176:191], v[204:207], v[44:47], v[176:191]
    ds_read_b64_tr_b16 v[192:193], v24 offset:16384
    ds_read_b64_tr_b16 v[194:195], v25 offset:18432
    v_exp_f32 v156, v156
    v_cvt_pk_bf16_f32 v153, v154, v155
    s_waitcnt lgkmcnt(4)
    v_mfma_f32_32x32x16_bf16 v[176:191], v[208:211], v[48:51], v[176:191]
    ds_read_b64_tr_b16 v[196:197], v26 offset:16384
    ds_read_b64_tr_b16 v[198:199], v27 offset:18432
    v_exp_f32 v157, v157
    v_exp_f32 v158, v158
    v_cvt_pk_bf16_f32 v154, v156, v157
    v_mfma_f32_32x32x16_bf16 v[176:191], v[212:215], v[52:55], v[176:191]
    ds_read_b64_tr_b16 v[200:201], v28 offset:16384
    ds_read_b64_tr_b16 v[202:203], v29 offset:18432
    v_exp_f32 v159, v159
    v_dot2_f32_bf16 v248, v152, s69, v248
    s_waitcnt lgkmcnt(6)
    v_mfma_f32_32x32x16_bf16 v[176:191], v[216:219], v[56:59], v[176:191]
    ds_read_b64_tr_b16 v[204:205], v30 offset:16384
    ds_read_b64_tr_b16 v[206:207], v31 offset:18432
    v_cvt_pk_bf16_f32 v155, v158, v159
    v_dot2_f32_bf16 v249, v153, s69, v249
    v_dot2_f32_bf16 v250, v154, s69, v250
    v_dot2_f32_bf16 v251, v155, s69, v251
    v_mfma_f32_32x32x16_bf16 v[176:191], v[220:223], v[60:63], v[176:191]
    ds_read_b64_tr_b16 v[208:209], v24 offset:20480
    ds_read_b64_tr_b16 v[210:211], v25 offset:22528
    s_cmp_lg_u64 s[74:75], 0
    s_cbranch_scc0 L_noresc6
    v_mul_f32 v64, v64, v9
    v_mul_f32 v65, v65, v9
    v_mul_f32 v66, v66, v9
    v_mul_f32 v67, v67, v9
    v_mul_f32 v68, v68, v9
    v_mul_f32 v69, v69, v9
    v_mul_f32 v70, v70, v9
    v_mul_f32 v71, v71, v9
    v_mul_f32 v72, v72, v9
    v_mul_f32 v73, v73, v9
    v_mul_f32 v74, v74, v9
    v_mul_f32 v75, v75, v9
    v_mul_f32 v76, v76, v9
    v_mul_f32 v77, v77, v9
    v_mul_f32 v78, v78, v9
    v_mul_f32 v79, v79, v9
    v_mul_f32 v80, v80, v9
    v_mul_f32 v81, v81, v9
    v_mul_f32 v82, v82, v9
    v_mul_f32 v83, v83, v9
    v_mul_f32 v84, v84, v9
    v_mul_f32 v85, v85, v9
    v_mul_f32 v86, v86, v9
    v_mul_f32 v87, v87, v9
    v_mul_f32 v88, v88, v9
    v_mul_f32 v89, v89, v9
    v_mul_f32 v90, v90, v9
    v_mul_f32 v91, v91, v9
    v_mul_f32 v92, v92, v9
    v_mul_f32 v93, v93, v9
    v_mul_f32 v94, v94, v9
    v_mul_f32 v95, v95, v9
    v_mul_f32 v96, v96, v9
    v_mul_f32 v97, v97, v9
    v_mul_f32 v98, v98, v9
    v_mul_f32 v99, v99, v9
    v_mul_f32 v100, v100, v9
    v_mul_f32 v101, v101, v9
    v_mul_f32 v102, v102, v9
    v_mul_f32 v103, v103, v9
    v_mul_f32 v104, v104, v9
    v_mul_f32 v105, v105, v9
    v_mul_f32 v106, v106, v9
    v_mul_f32 v107, v107, v9
    v_mul_f32 v108, v108, v9
    v_mul_f32 v109, v109, v9
    v_mul_f32 v110, v110, v9
    v_mul_f32 v111, v111, v9
    v_mul_f32 v112, v112, v9
    v_mul_f32 v113, v113, v9
    v_mul_f32 v114, v114, v9
    v_mul_f32 v115, v115, v9
    v_mul_f32 v116, v116, v9
    v_mul_f32 v117, v117, v9
    v_mul_f32 v118, v118, v9
    v_mul_f32 v119, v119, v9
    v_mul_f32 v120, v120, v9
    v_mul_f32 v121, v121, v9
    v_mul_f32 v122, v122, v9
    v_mul_f32 v123, v123, v9
    v_mul_f32 v124, v124, v9
    v_mul_f32 v125, v125, v9
    v_mul_f32 v126, v126, v9
    v_mul_f32 v127, v127, v9
    s_mov_b64 s[74:75], 0
    s_nop 1
L_noresc6:
    s_barrier
    s_waitcnt lgkmcnt(6)
    v_mfma_f32_32x32x16_bf16 v[64:79], v[192:195], v[128:131], v[64:79]
    ds_read_b64_tr_b16 v[212:213], v26 offset:20480
    ds_read_b64_tr_b16 v[214:215], v27 offset:22528
    v_max3_f32 v10, v160, v161, v162
    s_nop 1
    v_max3_f32 v15, v176, v177, v178
    v_max3_f32 v10, v10, v163, v164
    v_max3_f32 v15, v15, v179, v180
    v_max3_f32 v10, v10, v165, v166
    v_max3_f32 v15, v15, v181, v182
    v_max3_f32 v10, v10, v167, v168
    v_max3_f32 v15, v15, v183, v184
    v_mfma_f32_32x32x16_bf16 v[80:95], v[196:199], v[128:131], v[80:95]
    ds_read_b64_tr_b16 v[216:217], v28 offset:20480
    ds_read_b64_tr_b16 v[218:219], v29 offset:22528
    v_max3_f32 v10, v10, v169, v170
    v_max3_f32 v15, v15, v185, v186
    v_max3_f32 v10, v10, v171, v172
    v_max3_f32 v15, v15, v187, v188
    v_max3_f32 v10, v10, v173, v174
    v_max3_f32 v15, v15, v189, v190
    v_max3_f32 v10, v10, v175, v191
    s_waitcnt lgkmcnt(6)
    v_mfma_f32_32x32x16_bf16 v[96:111], v[200:203], v[128:131], v[96:111]
    ds_read_b64_tr_b16 v[220:221], v30 offset:20480
    ds_read_b64_tr_b16 v[222:223], v31 offset:22528
    v_max_f32 v10, v10, v15
    v_cmp_lt_f32 vcc, s59, v10
    s_cbranch_vccz L_noupd7
    s_nop 2
    v_mov_b32 v15, v10
    s_nop 1
    v_permlane32_swap_b32 v10, v15
    v_max_f32 v10, v10, v15
    v_cmp_lt_f32 vcc, s59, v10
    s_nop 1
    v_cndmask_b32 v10, 0, v10, vcc
    v_exp_f32 v9, -v10
    v_sub_f32 v160, v160, v10
    v_sub_f32 v161, v161, v10
    v_sub_f32 v162, v162, v10
    v_sub_f32 v163, v163, v10
    v_sub_f32 v164, v164, v10
    v_sub_f32 v165, v165, v10
    v_sub_f32 v166, v166, v10
    v_sub_f32 v167, v167, v10
    v_sub_f32 v168, v168, v10
    v_sub_f32 v169, v169, v10
    v_sub_f32 v170, v170, v10
    v_sub_f32 v171, v171, v10
    v_sub_f32 v172, v172, v10
    v_sub_f32 v173, v173, v10
    v_sub_f32 v174, v174, v10
    v_sub_f32 v175, v175, v10
    v_sub_f32 v176, v176, v10
    v_sub_f32 v177, v177, v10
    v_sub_f32 v178, v178, v10
    v_sub_f32 v179, v179, v10
    v_sub_f32 v180, v180, v10
    v_sub_f32 v181, v181, v10
    v_sub_f32 v182, v182, v10
    v_sub_f32 v183, v183, v10
    v_sub_f32 v184, v184, v10
    v_sub_f32 v185, v185, v10
    v_sub_f32 v186, v186, v10
    v_sub_f32 v187, v187, v10
    v_sub_f32 v188, v188, v10
    v_sub_f32 v189, v189, v10
    v_sub_f32 v190, v190, v10
    v_sub_f32 v191, v191, v10
    v_sub_f32 v224, v224, v10
    v_sub_f32 v225, v225, v10
    v_sub_f32 v226, v226, v10
    v_sub_f32 v227, v227, v10
    v_sub_f32 v228, v228, v10
    v_sub_f32 v229, v229, v10
    v_sub_f32 v230, v230, v10
    v_sub_f32 v231, v231, v10
    v_sub_f32 v232, v232, v10
    v_sub_f32 v233, v233, v10
    v_sub_f32 v234, v234, v10
    v_sub_f32 v235, v235, v10
    v_sub_f32 v236, v236, v10
    v_sub_f32 v237, v237, v10
    v_sub_f32 v238, v238, v10
    v_sub_f32 v239, v239, v10
    v_mul_f32 v248, v248, v9
    v_mul_f32 v249, v249, v9
    v_mul_f32 v250, v250, v9
    v_mul_f32 v251, v251, v9
    s_mov_b64 s[74:75], -1
    s_nop 1
L_noupd7:
    v_exp_f32 v160, v160
    v_exp_f32 v161, v161
    v_mfma_f32_32x32x16_bf16 v[112:127], v[204:207], v[128:131], v[112:127]
    ds_read_b64_tr_b16 v[192:193], v24 offset:24576
    ds_read_b64_tr_b16 v[194:195], v25 offset:26624
    v_exp_f32 v162, v162
    v_cvt_pk_bf16_f32 v160, v160, v161
    v_exp_f32 v163, v163
    v_exp_f32 v164, v164
    v_cvt_pk_bf16_f32 v161, v162, v163
    s_waitcnt lgkmcnt(6)
    v_mfma_f32_32x32x16_bf16 v[64:79], v[208:211], v[136:139], v[64:79]
    ds_read_b64_tr_b16 v[196:197], v26 offset:24576
    ds_read_b64_tr_b16 v[198:199], v27 offset:26624
    v_exp_f32 v165, v165
    v_exp_f32 v166, v166
    v_cvt_pk_bf16_f32 v162, v164, v165
    v_exp_f32 v167, v167
    v_dot2_f32_bf16 v248, v160, s69, v248
    v_mfma_f32_32x32x16_bf16 v[80:95], v[212:215], v[136:139], v[80:95]
    ds_read_b64_tr_b16 v[200:201], v28 offset:24576
    ds_read_b64_tr_b16 v[202:203], v29 offset:26624
    v_cvt_pk_bf16_f32 v163, v166, v167
    v_dot2_f32_bf16 v249, v161, s69, v249
    v_dot2_f32_bf16 v250, v162, s69, v250
    v_dot2_f32_bf16 v251, v163, s69, v251
    v_exp_f32 v168, v168
    v_exp_f32 v169, v169
    s_waitcnt lgkmcnt(6)
    v_mfma_f32_32x32x16_bf16 v[96:111], v[216:219], v[136:139], v[96:111]
    ds_read_b64_tr_b16 v[204:205], v30 offset:24576
    ds_read_b64_tr_b16 v[206:207], v31 offset:26624
    v_exp_f32 v170, v170
    v_cvt_pk_bf16_f32 v168, v168, v169
    v_exp_f32 v171, v171
    v_exp_f32 v172, v172
    v_mfma_f32_32x32x16_bf16 v[112:127], v[220:223], v[136:139], v[112:127]
    ds_read_b64_tr_b16 v[208:209], v24 offset:28672
    ds_read_b64_tr_b16 v[210:211], v25 offset:30720
    v_cvt_pk_bf16_f32 v169, v170, v171
    v_exp_f32 v173, v173
    v_exp_f32 v174, v174
    v_cvt_pk_bf16_f32 v170, v172, v173
    v_exp_f32 v175, v175
    s_waitcnt lgkmcnt(6)
    v_mfma_f32_32x32x16_bf16 v[64:79], v[192:195], v[144:147], v[64:79]
    ds_read_b64_tr_b16 v[212:213], v26 offset:28672
    ds_read_b64_tr_b16 v[214:215], v27 offset:30720
    v_dot2_f32_bf16 v248, v168, s69, v248
    v_cvt_pk_bf16_f32 v171, v174, v175
    v_dot2_f32_bf16 v249, v169, s69, v249
    v_dot2_f32_bf16 v250, v170, s69, v250
    v_dot2_f32_bf16 v251, v171, s69, v251
    v_exp_f32 v176, v176
    v_mfma_f32_32x32x16_bf16 v[80:95], v[196:199], v[144:147], v[80:95]
    ds_read_b64_tr_b16 v[216:217], v28 offset:28672
    ds_read_b64_tr_b16 v[218:219], v29 offset:30720
    v_exp_f32 v177, v177
    v_exp_f32 v178, v178
    v_cvt_pk_bf16_f32 v176, v176, v177
    v_exp_f32 v179, v179
    v_exp_f32 v180, v180
    s_waitcnt lgkmcnt(6)
    v_mfma_f32_32x32x16_bf16 v[96:111], v[200:203], v[144:147], v[96:111]
    ds_read_b64_tr_b16 v[220:221], v30 offset:28672
    ds_read_b64_tr_b16 v[222:223], v31 offset:30720
    v_cvt_pk_bf16_f32 v177, v178, v179
    v_exp_f32 v181, v181
    v_exp_f32 v182, v182
    v_cvt_pk_bf16_f32 v178, v180, v181
    v_mfma_f32_32x32x16_bf16 v[112:127], v[204:207], v[144:147], v[112:127]
    ds_read_b64_tr_b16 v[192:193], v24 offset:32768
    ds_read_b64_tr_b16 v[194:195], v25 offset:34816
    v_exp_f32 v183, v183
    v_dot2_f32_bf16 v248, v176, s69, v248
    v_cvt_pk_bf16_f32 v179, v182, v183
    v_dot2_f32_bf16 v249, v177, s69, v249
    v_dot2_f32_bf16 v250, v178, s69, v250
    v_dot2_f32_bf16 v251, v179, s69, v251
    v_exp_f32 v184, v184
    s_waitcnt lgkmcnt(6)
    v_mfma_f32_32x32x16_bf16 v[64:79], v[208:211], v[152:155], v[64:79]
    ds_read_b64_tr_b16 v[196:197], v26 offset:32768
    ds_read_b64_tr_b16 v[198:199], v27 offset:34816
    v_exp_f32 v185, v185
    v_exp_f32 v186, v186
    v_cvt_pk_bf16_f32 v184, v184, v185
    v_exp_f32 v187, v187
    v_mfma_f32_32x32x16_bf16 v[80:95], v[212:215], v[152:155], v[80:95]
    ds_read_b64_tr_b16 v[200:201], v28 offset:32768
    ds_read_b64_tr_b16 v[202:203], v29 offset:34816
    v_exp_f32 v188, v188
    v_cvt_pk_bf16_f32 v185, v186, v187
    v_exp_f32 v189, v189
    v_exp_f32 v190, v190
    s_waitcnt lgkmcnt(6)
    v_mfma_f32_32x32x16_bf16 v[96:111], v[216:219], v[152:155], v[96:111]
    ds_read_b64_tr_b16 v[204:205], v30 offset:32768
    ds_read_b64_tr_b16 v[206:207], v31 offset:34816
    v_cvt_pk_bf16_f32 v186, v188, v189
    v_exp_f32 v191, v191
    v_dot2_f32_bf16 v248, v184, s69, v248
    v_cvt_pk_bf16_f32 v187, v190, v191
    v_dot2_f32_bf16 v249, v185, s69, v249
    v_dot2_f32_bf16 v250, v186, s69, v250
    v_dot2_f32_bf16 v251, v187, s69, v251
    v_mfma_f32_32x32x16_bf16 v[112:127], v[220:223], v[152:155], v[112:127]
    ds_read_b64_tr_b16 v[208:209], v24 offset:36864
    ds_read_b64_tr_b16 v[210:211], v25 offset:38912
    s_cmp_lg_u64 s[74:75], 0
    s_cbranch_scc0 L_noresc7
    v_mul_f32 v64, v64, v9
    v_mul_f32 v65, v65, v9
    v_mul_f32 v66, v66, v9
    v_mul_f32 v67, v67, v9
    v_mul_f32 v68, v68, v9
    v_mul_f32 v69, v69, v9
    v_mul_f32 v70, v70, v9
    v_mul_f32 v71, v71, v9
    v_mul_f32 v72, v72, v9
    v_mul_f32 v73, v73, v9
    v_mul_f32 v74, v74, v9
    v_mul_f32 v75, v75, v9
    v_mul_f32 v76, v76, v9
    v_mul_f32 v77, v77, v9
    v_mul_f32 v78, v78, v9
    v_mul_f32 v79, v79, v9
    v_mul_f32 v80, v80, v9
    v_mul_f32 v81, v81, v9
    v_mul_f32 v82, v82, v9
    v_mul_f32 v83, v83, v9
    v_mul_f32 v84, v84, v9
    v_mul_f32 v85, v85, v9
    v_mul_f32 v86, v86, v9
    v_mul_f32 v87, v87, v9
    v_mul_f32 v88, v88, v9
    v_mul_f32 v89, v89, v9
    v_mul_f32 v90, v90, v9
    v_mul_f32 v91, v91, v9
    v_mul_f32 v92, v92, v9
    v_mul_f32 v93, v93, v9
    v_mul_f32 v94, v94, v9
    v_mul_f32 v95, v95, v9
    v_mul_f32 v96, v96, v9
    v_mul_f32 v97, v97, v9
    v_mul_f32 v98, v98, v9
    v_mul_f32 v99, v99, v9
    v_mul_f32 v100, v100, v9
    v_mul_f32 v101, v101, v9
    v_mul_f32 v102, v102, v9
    v_mul_f32 v103, v103, v9
    v_mul_f32 v104, v104, v9
    v_mul_f32 v105, v105, v9
    v_mul_f32 v106, v106, v9
    v_mul_f32 v107, v107, v9
    v_mul_f32 v108, v108, v9
    v_mul_f32 v109, v109, v9
    v_mul_f32 v110, v110, v9
    v_mul_f32 v111, v111, v9
    v_mul_f32 v112, v112, v9
    v_mul_f32 v113, v113, v9
    v_mul_f32 v114, v114, v9
    v_mul_f32 v115, v115, v9
    v_mul_f32 v116, v116, v9
    v_mul_f32 v117, v117, v9
    v_mul_f32 v118, v118, v9
    v_mul_f32 v119, v119, v9
    v_mul_f32 v120, v120, v9
    v_mul_f32 v121, v121, v9
    v_mul_f32 v122, v122, v9
    v_mul_f32 v123, v123, v9
    v_mul_f32 v124, v124, v9
    v_mul_f32 v125, v125, v9
    v_mul_f32 v126, v126, v9
    v_mul_f32 v127, v127, v9
    s_mov_b64 s[74:75], 0
    s_nop 1
L_noresc7:
    s_barrier
    s_waitcnt lgkmcnt(6)
    v_mfma_f32_32x32x16_bf16 v[64:79], v[192:195], v[160:163], v[64:79]
    ds_read_b64_tr_b16 v[212:213], v26 offset:36864
    ds_read_b64_tr_b16 v[214:215], v27 offset:38912
    v_mfma_f32_32x32x16_bf16 v[80:95], v[196:199], v[160:163], v[80:95]
    ds_read_b64_tr_b16 v[216:217], v28 offset:36864
    ds_read_b64_tr_b16 v[218:219], v29 offset:38912
    s_waitcnt lgkmcnt(6)
    v_mfma_f32_32x32x16_bf16 v[96:111], v[200:203], v[160:163], v[96:111]
    ds_read_b64_tr_b16 v[220:221], v30 offset:36864
    ds_read_b64_tr_b16 v[222:223], v31 offset:38912
    v_mfma_f32_32x32x16_bf16 v[112:127], v[204:207], v[160:163], v[112:127]
    ds_read_b64_tr_b16 v[192:193], v24 offset:40960
    ds_read_b64_tr_b16 v[194:195], v25 offset:43008
    s_waitcnt lgkmcnt(6)
    v_mfma_f32_32x32x16_bf16 v[64:79], v[208:211], v[168:171], v[64:79]
    ds_read_b64_tr_b16 v[196:197], v26 offset:40960
    ds_read_b64_tr_b16 v[198:199], v27 offset:43008
    v_mfma_f32_32x32x16_bf16 v[80:95], v[212:215], v[168:171], v[80:95]
    ds_read_b64_tr_b16 v[200:201], v28 offset:40960
    ds_read_b64_tr_b16 v[202:203], v29 offset:43008
    s_waitcnt lgkmcnt(6)
    v_mfma_f32_32x32x16_bf16 v[96:111], v[216:219], v[168:171], v[96:111]
    ds_read_b64_tr_b16 v[204:205], v30 offset:40960
    ds_read_b64_tr_b16 v[206:207], v31 offset:43008
    v_mfma_f32_32x32x16_bf16 v[112:127], v[220:223], v[168:171], v[112:127]
    ds_read_b64_tr_b16 v[208:209], v24 offset:45056
    ds_read_b64_tr_b16 v[210:211], v25 offset:47104
    s_waitcnt lgkmcnt(6)
    v_mfma_f32_32x32x16_bf16 v[64:79], v[192:195], v[176:179], v[64:79]
    ds_read_b64_tr_b16 v[212:213], v26 offset:45056
    ds_read_b64_tr_b16 v[214:215], v27 offset:47104
    v_mfma_f32_32x32x16_bf16 v[80:95], v[196:199], v[176:179], v[80:95]
    ds_read_b64_tr_b16 v[216:217], v28 offset:45056
    ds_read_b64_tr_b16 v[218:219], v29 offset:47104
    s_waitcnt lgkmcnt(6)
    v_mfma_f32_32x32x16_bf16 v[96:111], v[200:203], v[176:179], v[96:111]
    ds_read_b64_tr_b16 v[220:221], v30 offset:45056
    ds_read_b64_tr_b16 v[222:223], v31 offset:47104
    v_mfma_f32_32x32x16_bf16 v[112:127], v[204:207], v[176:179], v[112:127]
    s_waitcnt lgkmcnt(4)
    v_mfma_f32_32x32x16_bf16 v[64:79], v[208:211], v[184:187], v[64:79]
    v_mfma_f32_32x32x16_bf16 v[80:95], v[212:215], v[184:187], v[80:95]
    s_waitcnt lgkmcnt(0)
    v_mfma_f32_32x32x16_bf16 v[96:111], v[216:219], v[184:187], v[96:111]
    v_mfma_f32_32x32x16_bf16 v[112:127], v[220:223], v[184:187], v[112:127]
    v_subrev_u32 v5, 0x1c000, v5
    s_and_b32 s76, s3, 1
    s_lshl_b32 s76, s76, 13
    s_cmp_ge_u32 s3, 2
    s_mov_b32 s64, 0xc000
    s_mov_b32 s65, 0x20000
    s_cselect_b32 s60, s65, s64
    s_mov_b32 s64, 0x0
    s_mov_b32 s65, 0x1c000
    s_cselect_b32 s61, s65, s64
    s_mov_b32 s64, 0x24000
    s_mov_b32 s65, 0x10000
    s_cselect_b32 s62, s65, s64
    s_add_u32 s60, s60, s76
    s_add_u32 s61, s61, s76
    s_add_u32 s62, s62, s76
    buffer_load_dwordx4 v[128:131], v3, s[48:51], s68 offen
    buffer_load_dwordx4 v[132:135], v3, s[48:51], s68 offen offset:1024
    buffer_load_dwordx4 v[136:139], v3, s[48:51], s68 offen offset:2048
    buffer_load_dwordx4 v[140:143], v3, s[48:51], s68 offen offset:3072
    buffer_load_dwordx4 v[144:147], v4, s[48:51], s68 offen
    buffer_load_dwordx4 v[148:151], v4, s[48:51], s68 offen offset:1024
    buffer_load_dwordx4 v[152:155], v4, s[48:51], s68 offen offset:2048
    buffer_load_dwordx4 v[156:159], v4, s[48:51], s68 offen offset:3072
    s_add_u32 s79, s79, 0x8000
    s_and_b32 s79, s79, 0x7ffff
    s_or_b32 s68, s79, s77
    buffer_load_dwordx4 v[160:163], v3, s[48:51], s68 offen
    buffer_load_dwordx4 v[164:167], v3, s[48:51], s68 offen offset:1024
    buffer_load_dwordx4 v[168:171], v3, s[48:51], s68 offen offset:2048
    buffer_load_dwordx4 v[172:175], v3, s[48:51], s68 offen offset:3072
    buffer_load_dwordx4 v[176:179], v4, s[48:51], s68 offen
    buffer_load_dwordx4 v[180:183], v4, s[48:51], s68 offen offset:1024
    buffer_load_dwordx4 v[184:187], v4, s[48:51], s68 offen offset:2048
    buffer_load_dwordx4 v[188:191], v4, s[48:51], s68 offen offset:3072
    s_add_u32 s79, s79, 0x8000
    s_and_b32 s79, s79, 0x7ffff
    s_or_b32 s68, s79, s77
    buffer_load_dwordx4 v[192:195], v3, s[48:51], s68 offen
    buffer_load_dwordx4 v[196:199], v3, s[48:51], s68 offen offset:1024
    buffer_load_dwordx4 v[200:203], v3, s[48:51], s68 offen offset:2048
    buffer_load_dwordx4 v[204:207], v3, s[48:51], s68 offen offset:3072
    buffer_load_dwordx4 v[208:211], v4, s[48:51], s68 offen
    buffer_load_dwordx4 v[212:215], v4, s[48:51], s68 offen offset:1024
    buffer_load_dwordx4 v[216:219], v4, s[48:51], s68 offen offset:2048
    buffer_load_dwordx4 v[220:223], v4, s[48:51], s68 offen offset:3072
    s_add_u32 s79, s79, 0x8000
    s_and_b32 s79, s79, 0x7ffff
    s_or_b32 s68, s79, s77
    v_add_f32 v8, v248, v249
    v_add_f32 v15, v250, v251
    v_add_f32 v8, v8, v15
    v_mov_b32 v15, v8
    s_nop 1
    v_permlane32_swap_b32 v8, v15
    v_add_f32 v8, v8, v15
    v_rcp_f32 v8, v8
    s_nop 0
    v_mul_f32 v64, v64, v8
    v_mul_f32 v65, v65, v8
    v_mul_f32 v66, v66, v8
    v_mul_f32 v67, v67, v8
    v_mul_f32 v68, v68, v8
    v_mul_f32 v69, v69, v8
    v_mul_f32 v70, v70, v8
    v_mul_f32 v71, v71, v8
    v_cvt_pk_bf16_f32 v224, v64, v65
    v_cvt_pk_bf16_f32 v225, v66, v67
    v_cvt_pk_bf16_f32 v226, v68, v69
    v_cvt_pk_bf16_f32 v227, v70, v71
    ds_write_b128 v14, v[224:227] offset:0
    v_mul_f32 v72, v72, v8
    v_mul_f32 v73, v73, v8
    v_mul_f32 v74, v74, v8
    v_mul_f32 v75, v75, v8
    v_mul_f32 v76, v76, v8
    v_mul_f32 v77, v77, v8
    v_mul_f32 v78, v78, v8
    v_mul_f32 v79, v79, v8
    v_cvt_pk_bf16_f32 v228, v72, v73
    v_cvt_pk_bf16_f32 v229, v74, v75
    v_cvt_pk_bf16_f32 v230, v76, v77
    v_cvt_pk_bf16_f32 v231, v78, v79
    ds_write_b128 v14, v[228:231] offset:512
    v_mul_f32 v80, v80, v8
    v_mul_f32 v81, v81, v8
    v_mul_f32 v82, v82, v8
    v_mul_f32 v83, v83, v8
    v_mul_f32 v84, v84, v8
    v_mul_f32 v85, v85, v8
    v_mul_f32 v86, v86, v8
    v_mul_f32 v87, v87, v8
    v_cvt_pk_bf16_f32 v232, v80, v81
    v_cvt_pk_bf16_f32 v233, v82, v83
    v_cvt_pk_bf16_f32 v234, v84, v85
    v_cvt_pk_bf16_f32 v235, v86, v87
    ds_write_b128 v14, v[232:235] offset:2048
    v_mul_f32 v88, v88, v8
    v_mul_f32 v89, v89, v8
    v_mul_f32 v90, v90, v8
    v_mul_f32 v91, v91, v8
    v_mul_f32 v92, v92, v8
    v_mul_f32 v93, v93, v8
    v_mul_f32 v94, v94, v8
    v_mul_f32 v95, v95, v8
    v_cvt_pk_bf16_f32 v236, v88, v89
    v_cvt_pk_bf16_f32 v237, v90, v91
    v_cvt_pk_bf16_f32 v238, v92, v93
    v_cvt_pk_bf16_f32 v239, v94, v95
    ds_write_b128 v14, v[236:239] offset:2560
    v_mul_f32 v96, v96, v8
    v_mul_f32 v97, v97, v8
    v_mul_f32 v98, v98, v8
    v_mul_f32 v99, v99, v8
    v_mul_f32 v100, v100, v8
    v_mul_f32 v101, v101, v8
    v_mul_f32 v102, v102, v8
    v_mul_f32 v103, v103, v8
    v_cvt_pk_bf16_f32 v240, v96, v97
    v_cvt_pk_bf16_f32 v241, v98, v99
    v_cvt_pk_bf16_f32 v242, v100, v101
    v_cvt_pk_bf16_f32 v243, v102, v103
    ds_write_b128 v14, v[240:243] offset:4096
    v_mul_f32 v104, v104, v8
    v_mul_f32 v105, v105, v8
    v_mul_f32 v106, v106, v8
    v_mul_f32 v107, v107, v8
    v_mul_f32 v108, v108, v8
    v_mul_f32 v109, v109, v8
    v_mul_f32 v110, v110, v8
    v_mul_f32 v111, v111, v8
    v_cvt_pk_bf16_f32 v244, v104, v105
    v_cvt_pk_bf16_f32 v245, v106, v107
    v_cvt_pk_bf16_f32 v246, v108, v109
    v_cvt_pk_bf16_f32 v247, v110, v111
    ds_write_b128 v14, v[244:247] offset:4608
    v_mul_f32 v112, v112, v8
    v_mul_f32 v113, v113, v8
    v_mul_f32 v114, v114, v8
    v_mul_f32 v115, v115, v8
    v_mul_f32 v116, v116, v8
    v_mul_f32 v117, v117, v8
    v_mul_f32 v118, v118, v8
    v_mul_f32 v119, v119, v8
    v_cvt_pk_bf16_f32 v248, v112, v113
    v_cvt_pk_bf16_f32 v249, v114, v115
    v_cvt_pk_bf16_f32 v250, v116, v117
    v_cvt_pk_bf16_f32 v251, v118, v119
    ds_write_b128 v14, v[248:251] offset:6144
    v_mul_f32 v120, v120, v8
    v_mul_f32 v121, v121, v8
    v_mul_f32 v122, v122, v8
    v_mul_f32 v123, v123, v8
    v_mul_f32 v124, v124, v8
    v_mul_f32 v125, v125, v8
    v_mul_f32 v126, v126, v8
    v_mul_f32 v127, v127, v8
    v_cvt_pk_bf16_f32 v252, v120, v121
    v_cvt_pk_bf16_f32 v253, v122, v123
    v_cvt_pk_bf16_f32 v254, v124, v125
    v_cvt_pk_bf16_f32 v255, v126, v127
    ds_write_b128 v14, v[252:255] offset:6656
    s_waitcnt lgkmcnt(0)
    s_barrier
    v_add_u32 v10, s78, v5
    s_add_u32 s78, s78, 0x800
    s_and_b32 s78, s78, 0x7fff
    ds_read_b128 v[32:35], v10 offset:0
    ds_read_b128 v[36:39], v10 offset:1024
    v_add_u32 v15, s78, v5
    s_add_u32 s78, s78, 0x800
    s_and_b32 s78, s78, 0x7fff
    ds_read_b128 v[40:43], v15 offset:0
    ds_read_b128 v[44:47], v15 offset:1024
    s_waitcnt vmcnt(22)
    v_perm_b32 v224, v132, v128, s56
    s_waitcnt vmcnt(20)
    v_perm_b32 v225, v140, v136, s56
    s_waitcnt vmcnt(18)
    v_perm_b32 v226, v148, v144, s56
    s_waitcnt vmcnt(16)
    v_perm_b32 v227, v156, v152, s56
    v_perm_b32 v228, v132, v128, s57
    v_perm_b32 v229, v140, v136, s57
    v_perm_b32 v230, v148, v144, s57
    v_perm_b32 v231, v156, v152, s57
    v_perm_b32 v232, v133, v129, s56
    v_perm_b32 v233, v141, v137, s56
    v_perm_b32 v234, v149, v145, s56
    v_perm_b32 v235, v157, v153, s56
    v_perm_b32 v236, v133, v129, s57
    v_perm_b32 v237, v141, v137, s57
    v_perm_b32 v238, v149, v145, s57
    v_perm_b32 v239, v157, v153, s57
    v_perm_b32 v240, v134, v130, s56
    v_perm_b32 v241, v142, v138, s56
    v_perm_b32 v242, v150, v146, s56
    v_perm_b32 v243, v158, v154, s56
    v_perm_b32 v244, v134, v130, s57
    v_perm_b32 v245, v142, v138, s57
    v_perm_b32 v246, v150, v146, s57
    v_perm_b32 v247, v158, v154, s57
    v_perm_b32 v248, v135, v131, s56
    v_perm_b32 v249, v143, v139, s56
    v_perm_b32 v250, v151, v147, s56
    v_perm_b32 v251, v159, v155, s56
    v_perm_b32 v252, v135, v131, s57
    v_perm_b32 v253, v143, v139, s57
    v_perm_b32 v254, v151, v147, s57
    v_perm_b32 v255, v159, v155, s57
    s_waitcnt lgkmcnt(3)
    v_mfma_f32_16x16x32_bf16 v[64:67], v[224:227], v[32:35], 0
    s_waitcnt lgkmcnt(2)
    v_mfma_f32_16x16x32_bf16 v[68:71], v[224:227], v[36:39], 0
    s_waitcnt vmcnt(14)
    v_perm_b32 v224, v164, v160, s56
    s_waitcnt vmcnt(12)
    v_perm_b32 v225, v172, v168, s56
    s_waitcnt vmcnt(10)
    v_perm_b32 v226, v180, v176, s56
    s_waitcnt vmcnt(8)
    v_perm_b32 v227, v188, v184, s56
    buffer_load_dwordx4 v[128:131], v3, s[48:51], s68 offen
    v_mfma_f32_16x16x32_bf16 v[72:75], v[228:231], v[32:35], 0
    v_mfma_f32_16x16x32_bf16 v[76:79], v[228:231], v[36:39], 0
    v_perm_b32 v228, v164, v160, s57
    v_perm_b32 v229, v172, v168, s57
    v_perm_b32 v230, v180, v176, s57
    v_perm_b32 v231, v188, v184, s57
    buffer_load_dwordx4 v[132:135], v3, s[48:51], s68 offen offset:1024
    v_mfma_f32_16x16x32_bf16 v[80:83], v[232:235], v[32:35], 0
    v_mfma_f32_16x16x32_bf16 v[84:87], v[232:235], v[36:39], 0
    v_perm_b32 v232, v165, v161, s56
    v_perm_b32 v233, v173, v169, s56
    v_perm_b32 v234, v181, v177, s56
    v_perm_b32 v235, v189, v185, s56
    buffer_load_dwordx4 v[136:139], v3, s[48:51], s68 offen offset:2048
    v_mfma_f32_16x16x32_bf16 v[88:91], v[236:239], v[32:35], 0
    v_mfma_f32_16x16x32_bf16 v[92:95], v[236:239], v[36:39], 0
    v_perm_b32 v236, v165, v161, s57
    v_perm_b32 v237, v173, v169, s57
    v_perm_b32 v238, v181, v177, s57
    v_perm_b32 v239, v189, v185, s57
    buffer_load_dwordx4 v[140:143], v3, s[48:51], s68 offen offset:3072
    v_mfma_f32_16x16x32_bf16 v[96:99], v[240:243], v[32:35], 0
    v_mfma_f32_16x16x32_bf16 v[100:103], v[240:243], v[36:39], 0
    v_perm_b32 v240, v166, v162, s56
    v_perm_b32 v241, v174, v170, s56
    v_perm_b32 v242, v182, v178, s56
    v_perm_b32 v243, v190, v186, s56
    buffer_load_dwordx4 v[144:147], v4, s[48:51], s68 offen
    v_mfma_f32_16x16x32_bf16 v[104:107], v[244:247], v[32:35], 0
    v_mfma_f32_16x16x32_bf16 v[108:111], v[244:247], v[36:39], 0
    v_perm_b32 v244, v166, v162, s57
    v_perm_b32 v245, v174, v170, s57
    v_perm_b32 v246, v182, v178, s57
    v_perm_b32 v247, v190, v186, s57
    buffer_load_dwordx4 v[148:151], v4, s[48:51], s68 offen offset:1024
    v_mfma_f32_16x16x32_bf16 v[112:115], v[248:251], v[32:35], 0
    v_mfma_f32_16x16x32_bf16 v[116:119], v[248:251], v[36:39], 0
    v_perm_b32 v248, v167, v163, s56
    v_perm_b32 v249, v175, v171, s56
    v_perm_b32 v250, v183, v179, s56
    v_perm_b32 v251, v191, v187, s56
    buffer_load_dwordx4 v[152:155], v4, s[48:51], s68 offen offset:2048
    v_mfma_f32_16x16x32_bf16 v[120:123], v[252:255], v[32:35], 0
    v_mfma_f32_16x16x32_bf16 v[124:127], v[252:255], v[36:39], 0
    v_add_u32 v10, s78, v5
    s_add_u32 s78, s78, 0x800
    s_and_b32 s78, s78, 0x7fff
    ds_read_b128 v[32:35], v10 offset:0
    ds_read_b128 v[36:39], v10 offset:1024
    v_perm_b32 v252, v167, v163, s57
    v_perm_b32 v253, v175, v171, s57
    v_perm_b32 v254, v183, v179, s57
    v_perm_b32 v255, v191, v187, s57
    buffer_load_dwordx4 v[156:159], v4, s[48:51], s68 offen offset:3072
    s_add_u32 s79, s79, 0x8000
    s_and_b32 s79, s79, 0x7ffff
    s_or_b32 s68, s79, s77
    s_waitcnt lgkmcnt(3)
    v_mfma_f32_16x16x32_bf16 v[64:67], v[224:227], v[40:43], v[64:67]
    s_waitcnt lgkmcnt(2)
    v_mfma_f32_16x16x32_bf16 v[68:71], v[224:227], v[44:47], v[68:71]
    s_waitcnt vmcnt(14)
    v_perm_b32 v224, v196, v192, s56
    s_waitcnt vmcnt(12)
    v_perm_b32 v225, v204, v200, s56
    s_waitcnt vmcnt(10)
    v_perm_b32 v226, v212, v208, s56
    s_waitcnt vmcnt(8)
    v_perm_b32 v227, v220, v216, s56
    buffer_load_dwordx4 v[160:163], v3, s[48:51], s68 offen
    v_mfma_f32_16x16x32_bf16 v[72:75], v[228:231], v[40:43], v[72:75]
    v_mfma_f32_16x16x32_bf16 v[76:79], v[228:231], v[44:47], v[76:79]
    v_perm_b32 v228, v196, v192, s57
    v_perm_b32 v229, v204, v200, s57
    v_perm_b32 v230, v212, v208, s57
    v_perm_b32 v231, v220, v216, s57
    buffer_load_dwordx4 v[164:167], v3, s[48:51], s68 offen offset:1024
    v_mfma_f32_16x16x32_bf16 v[80:83], v[232:235], v[40:43], v[80:83]
    v_mfma_f32_16x16x32_bf16 v[84:87], v[232:235], v[44:47], v[84:87]
    v_perm_b32 v232, v197, v193, s56
    v_perm_b32 v233, v205, v201, s56
    v_perm_b32 v234, v213, v209, s56
    v_perm_b32 v235, v221, v217, s56
    buffer_load_dwordx4 v[168:171], v3, s[48:51], s68 offen offset:2048
    v_mfma_f32_16x16x32_bf16 v[88:91], v[236:239], v[40:43], v[88:91]
    v_mfma_f32_16x16x32_bf16 v[92:95], v[236:239], v[44:47], v[92:95]
    v_perm_b32 v236, v197, v193, s57
    v_perm_b32 v237, v205, v201, s57
    v_perm_b32 v238, v213, v209, s57
    v_perm_b32 v239, v221, v217, s57
    buffer_load_dwordx4 v[172:175], v3, s[48:51], s68 offen offset:3072
    v_mfma_f32_16x16x32_bf16 v[96:99], v[240:243], v[40:43], v[96:99]
    v_mfma_f32_16x16x32_bf16 v[100:103], v[240:243], v[44:47], v[100:103]
    v_perm_b32 v240, v198, v194, s56
    v_perm_b32 v241, v206, v202, s56
    v_perm_b32 v242, v214, v210, s56
    v_perm_b32 v243, v222, v218, s56
    buffer_load_dwordx4 v[176:179], v4, s[48:51], s68 offen
    v_mfma_f32_16x16x32_bf16 v[104:107], v[244:247], v[40:43], v[104:107]
    v_mfma_f32_16x16x32_bf16 v[108:111], v[244:247], v[44:47], v[108:111]
    v_perm_b32 v244, v198, v194, s57
    v_perm_b32 v245, v206, v202, s57
    v_perm_b32 v246, v214, v210, s57
    v_perm_b32 v247, v222, v218, s57
    buffer_load_dwordx4 v[180:183], v4, s[48:51], s68 offen offset:1024
    v_mfma_f32_16x16x32_bf16 v[112:115], v[248:251], v[40:43], v[112:115]
    v_mfma_f32_16x16x32_bf16 v[116:119], v[248:251], v[44:47], v[116:119]
    v_perm_b32 v248, v199, v195, s56
    v_perm_b32 v249, v207, v203, s56
    v_perm_b32 v250, v215, v211, s56
    v_perm_b32 v251, v223, v219, s56
    buffer_load_dwordx4 v[184:187], v4, s[48:51], s68 offen offset:2048
    v_mfma_f32_16x16x32_bf16 v[120:123], v[252:255], v[40:43], v[120:123]
    v_mfma_f32_16x16x32_bf16 v[124:127], v[252:255], v[44:47], v[124:127]
    v_add_u32 v15, s78, v5
    s_add_u32 s78, s78, 0x800
    s_and_b32 s78, s78, 0x7fff
    ds_read_b128 v[40:43], v15 offset:0
    ds_read_b128 v[44:47], v15 offset:1024
    v_perm_b32 v252, v199, v195, s57
    v_perm_b32 v253, v207, v203, s57
    v_perm_b32 v254, v215, v211, s57
    v_perm_b32 v255, v223, v219, s57
    buffer_load_dwordx4 v[188:191], v4, s[48:51], s68 offen offset:3072
    s_add_u32 s79, s79, 0x8000
    s_and_b32 s79, s79, 0x7ffff
    s_or_b32 s68, s79, s77
    s_waitcnt lgkmcnt(3)
    v_mfma_f32_16x16x32_bf16 v[64:67], v[224:227], v[32:35], v[64:67]
    s_waitcnt lgkmcnt(2)
    v_mfma_f32_16x16x32_bf16 v[68:71], v[224:227], v[36:39], v[68:71]
    s_waitcnt vmcnt(14)
    v_perm_b32 v224, v132, v128, s56
    s_waitcnt vmcnt(12)
    v_perm_b32 v225, v140, v136, s56
    s_waitcnt vmcnt(10)
    v_perm_b32 v226, v148, v144, s56
    s_waitcnt vmcnt(8)
    v_perm_b32 v227, v156, v152, s56
    buffer_load_dwordx4 v[192:195], v3, s[48:51], s68 offen
    v_mfma_f32_16x16x32_bf16 v[72:75], v[228:231], v[32:35], v[72:75]
    v_mfma_f32_16x16x32_bf16 v[76:79], v[228:231], v[36:39], v[76:79]
    v_perm_b32 v228, v132, v128, s57
    v_perm_b32 v229, v140, v136, s57
    v_perm_b32 v230, v148, v144, s57
    v_perm_b32 v231, v156, v152, s57
    buffer_load_dwordx4 v[196:199], v3, s[48:51], s68 offen offset:1024
    v_mfma_f32_16x16x32_bf16 v[80:83], v[232:235], v[32:35], v[80:83]
    v_mfma_f32_16x16x32_bf16 v[84:87], v[232:235], v[36:39], v[84:87]
    v_perm_b32 v232, v133, v129, s56
    v_perm_b32 v233, v141, v137, s56
    v_perm_b32 v234, v149, v145, s56
    v_perm_b32 v235, v157, v153, s56
    buffer_load_dwordx4 v[200:203], v3, s[48:51], s68 offen offset:2048
    v_mfma_f32_16x16x32_bf16 v[88:91], v[236:239], v[32:35], v[88:91]
    v_mfma_f32_16x16x32_bf16 v[92:95], v[236:239], v[36:39], v[92:95]
    v_perm_b32 v236, v133, v129, s57
    v_perm_b32 v237, v141, v137, s57
    v_perm_b32 v238, v149, v145, s57
    v_perm_b32 v239, v157, v153, s57
    buffer_load_dwordx4 v[204:207], v3, s[48:51], s68 offen offset:3072
    v_mfma_f32_16x16x32_bf16 v[96:99], v[240:243], v[32:35], v[96:99]
    v_mfma_f32_16x16x32_bf16 v[100:103], v[240:243], v[36:39], v[100:103]
    v_perm_b32 v240, v134, v130, s56
    v_perm_b32 v241, v142, v138, s56
    v_perm_b32 v242, v150, v146, s56
    v_perm_b32 v243, v158, v154, s56
    buffer_load_dwordx4 v[208:211], v4, s[48:51], s68 offen
    v_mfma_f32_16x16x32_bf16 v[104:107], v[244:247], v[32:35], v[104:107]
    v_mfma_f32_16x16x32_bf16 v[108:111], v[244:247], v[36:39], v[108:111]
    v_perm_b32 v244, v134, v130, s57
    v_perm_b32 v245, v142, v138, s57
    v_perm_b32 v246, v150, v146, s57
    v_perm_b32 v247, v158, v154, s57
    buffer_load_dwordx4 v[212:215], v4, s[48:51], s68 offen offset:1024
    v_mfma_f32_16x16x32_bf16 v[112:115], v[248:251], v[32:35], v[112:115]
    v_mfma_f32_16x16x32_bf16 v[116:119], v[248:251], v[36:39], v[116:119]
    v_perm_b32 v248, v135, v131, s56
    v_perm_b32 v249, v143, v139, s56
    v_perm_b32 v250, v151, v147, s56
    v_perm_b32 v251, v159, v155, s56
    buffer_load_dwordx4 v[216:219], v4, s[48:51], s68 offen offset:2048
    v_mfma_f32_16x16x32_bf16 v[120:123], v[252:255], v[32:35], v[120:123]
    v_mfma_f32_16x16x32_bf16 v[124:127], v[252:255], v[36:39], v[124:127]
    v_add_u32 v10, s78, v5
    s_add_u32 s78, s78, 0x800
    s_and_b32 s78, s78, 0x7fff
    ds_read_b128 v[32:35], v10 offset:0
    ds_read_b128 v[36:39], v10 offset:1024
    v_perm_b32 v252, v135, v131, s57
    v_perm_b32 v253, v143, v139, s57
    v_perm_b32 v254, v151, v147, s57
    v_perm_b32 v255, v159, v155, s57
    buffer_load_dwordx4 v[220:223], v4, s[48:51], s68 offen offset:3072
    s_add_u32 s79, s79, 0x8000
    s_and_b32 s79, s79, 0x7ffff
    s_or_b32 s68, s79, s77
    s_waitcnt lgkmcnt(3)
    v_mfma_f32_16x16x32_bf16 v[64:67], v[224:227], v[40:43], v[64:67]
    s_waitcnt lgkmcnt(2)
    v_mfma_f32_16x16x32_bf16 v[68:71], v[224:227], v[44:47], v[68:71]
    s_waitcnt vmcnt(14)
    v_perm_b32 v224, v164, v160, s56
    s_waitcnt vmcnt(12)
    v_perm_b32 v225, v172, v168, s56
    s_waitcnt vmcnt(10)
    v_perm_b32 v226, v180, v176, s56
    s_waitcnt vmcnt(8)
    v_perm_b32 v227, v188, v184, s56
    buffer_load_dwordx4 v[128:131], v3, s[48:51], s68 offen
    v_mfma_f32_16x16x32_bf16 v[72:75], v[228:231], v[40:43], v[72:75]
    v_mfma_f32_16x16x32_bf16 v[76:79], v[228:231], v[44:47], v[76:79]
    v_perm_b32 v228, v164, v160, s57
    v_perm_b32 v229, v172, v168, s57
    v_perm_b32 v230, v180, v176, s57
    v_perm_b32 v231, v188, v184, s57
    buffer_load_dwordx4 v[132:135], v3, s[48:51], s68 offen offset:1024
    v_mfma_f32_16x16x32_bf16 v[80:83], v[232:235], v[40:43], v[80:83]
    v_mfma_f32_16x16x32_bf16 v[84:87], v[232:235], v[44:47], v[84:87]
    v_perm_b32 v232, v165, v161, s56
    v_perm_b32 v233, v173, v169, s56
    v_perm_b32 v234, v181, v177, s56
    v_perm_b32 v235, v189, v185, s56
    buffer_load_dwordx4 v[136:139], v3, s[48:51], s68 offen offset:2048
    v_mfma_f32_16x16x32_bf16 v[88:91], v[236:239], v[40:43], v[88:91]
    v_mfma_f32_16x16x32_bf16 v[92:95], v[236:239], v[44:47], v[92:95]
    v_perm_b32 v236, v165, v161, s57
    v_perm_b32 v237, v173, v169, s57
    v_perm_b32 v238, v181, v177, s57
    v_perm_b32 v239, v189, v185, s57
    buffer_load_dwordx4 v[140:143], v3, s[48:51], s68 offen offset:3072
    v_mfma_f32_16x16x32_bf16 v[96:99], v[240:243], v[40:43], v[96:99]
    v_mfma_f32_16x16x32_bf16 v[100:103], v[240:243], v[44:47], v[100:103]
    v_perm_b32 v240, v166, v162, s56
    v_perm_b32 v241, v174, v170, s56
    v_perm_b32 v242, v182, v178, s56
    v_perm_b32 v243, v190, v186, s56
    buffer_load_dwordx4 v[144:147], v4, s[48:51], s68 offen
    v_mfma_f32_16x16x32_bf16 v[104:107], v[244:247], v[40:43], v[104:107]
    v_mfma_f32_16x16x32_bf16 v[108:111], v[244:247], v[44:47], v[108:111]
    v_perm_b32 v244, v166, v162, s57
    v_perm_b32 v245, v174, v170, s57
    v_perm_b32 v246, v182, v178, s57
    v_perm_b32 v247, v190, v186, s57
    buffer_load_dwordx4 v[148:151], v4, s[48:51], s68 offen offset:1024
    v_mfma_f32_16x16x32_bf16 v[112:115], v[248:251], v[40:43], v[112:115]
    v_mfma_f32_16x16x32_bf16 v[116:119], v[248:251], v[44:47], v[116:119]
    v_perm_b32 v248, v167, v163, s56
    v_perm_b32 v249, v175, v171, s56
    v_perm_b32 v250, v183, v179, s56
    v_perm_b32 v251, v191, v187, s56
    buffer_load_dwordx4 v[152:155], v4, s[48:51], s68 offen offset:2048
    v_mfma_f32_16x16x32_bf16 v[120:123], v[252:255], v[40:43], v[120:123]
    v_mfma_f32_16x16x32_bf16 v[124:127], v[252:255], v[44:47], v[124:127]
    v_add_u32 v15, s78, v5
    s_add_u32 s78, s78, 0x800
    s_and_b32 s78, s78, 0x7fff
    ds_read_b128 v[40:43], v15 offset:0
    ds_read_b128 v[44:47], v15 offset:1024
    v_perm_b32 v252, v167, v163, s57
    v_perm_b32 v253, v175, v171, s57
    v_perm_b32 v254, v183, v179, s57
    v_perm_b32 v255, v191, v187, s57
    buffer_load_dwordx4 v[156:159], v4, s[48:51], s68 offen offset:3072
    s_add_u32 s79, s79, 0x8000
    s_and_b32 s79, s79, 0x7ffff
    s_or_b32 s68, s79, s77
    s_waitcnt lgkmcnt(3)
    v_mfma_f32_16x16x32_bf16 v[64:67], v[224:227], v[32:35], v[64:67]
    s_waitcnt lgkmcnt(2)
    v_mfma_f32_16x16x32_bf16 v[68:71], v[224:227], v[36:39], v[68:71]
    s_waitcnt vmcnt(14)
    v_perm_b32 v224, v196, v192, s56
    s_waitcnt vmcnt(12)
    v_perm_b32 v225, v204, v200, s56
    s_waitcnt vmcnt(10)
    v_perm_b32 v226, v212, v208, s56
    s_waitcnt vmcnt(8)
    v_perm_b32 v227, v220, v216, s56
    buffer_load_dwordx4 v[160:163], v3, s[48:51], s68 offen
    v_mfma_f32_16x16x32_bf16 v[72:75], v[228:231], v[32:35], v[72:75]
    v_mfma_f32_16x16x32_bf16 v[76:79], v[228:231], v[36:39], v[76:79]
    v_perm_b32 v228, v196, v192, s57
    v_perm_b32 v229, v204, v200, s57
    v_perm_b32 v230, v212, v208, s57
    v_perm_b32 v231, v220, v216, s57
    buffer_load_dwordx4 v[164:167], v3, s[48:51], s68 offen offset:1024
    v_mfma_f32_16x16x32_bf16 v[80:83], v[232:235], v[32:35], v[80:83]
    v_mfma_f32_16x16x32_bf16 v[84:87], v[232:235], v[36:39], v[84:87]
    v_perm_b32 v232, v197, v193, s56
    v_perm_b32 v233, v205, v201, s56
    v_perm_b32 v234, v213, v209, s56
    v_perm_b32 v235, v221, v217, s56
    buffer_load_dwordx4 v[168:171], v3, s[48:51], s68 offen offset:2048
    v_mfma_f32_16x16x32_bf16 v[88:91], v[236:239], v[32:35], v[88:91]
    v_mfma_f32_16x16x32_bf16 v[92:95], v[236:239], v[36:39], v[92:95]
    v_perm_b32 v236, v197, v193, s57
    v_perm_b32 v237, v205, v201, s57
    v_perm_b32 v238, v213, v209, s57
    v_perm_b32 v239, v221, v217, s57
    buffer_load_dwordx4 v[172:175], v3, s[48:51], s68 offen offset:3072
    v_mfma_f32_16x16x32_bf16 v[96:99], v[240:243], v[32:35], v[96:99]
    v_mfma_f32_16x16x32_bf16 v[100:103], v[240:243], v[36:39], v[100:103]
    v_perm_b32 v240, v198, v194, s56
    v_perm_b32 v241, v206, v202, s56
    v_perm_b32 v242, v214, v210, s56
    v_perm_b32 v243, v222, v218, s56
    buffer_load_dwordx4 v[176:179], v4, s[48:51], s68 offen
    v_mfma_f32_16x16x32_bf16 v[104:107], v[244:247], v[32:35], v[104:107]
    v_mfma_f32_16x16x32_bf16 v[108:111], v[244:247], v[36:39], v[108:111]
    v_perm_b32 v244, v198, v194, s57
    v_perm_b32 v245, v206, v202, s57
    v_perm_b32 v246, v214, v210, s57
    v_perm_b32 v247, v222, v218, s57
    buffer_load_dwordx4 v[180:183], v4, s[48:51], s68 offen offset:1024
    v_mfma_f32_16x16x32_bf16 v[112:115], v[248:251], v[32:35], v[112:115]
    v_mfma_f32_16x16x32_bf16 v[116:119], v[248:251], v[36:39], v[116:119]
    v_perm_b32 v248, v199, v195, s56
    v_perm_b32 v249, v207, v203, s56
    v_perm_b32 v250, v215, v211, s56
    v_perm_b32 v251, v223, v219, s56
    buffer_load_dwordx4 v[184:187], v4, s[48:51], s68 offen offset:2048
    v_mfma_f32_16x16x32_bf16 v[120:123], v[252:255], v[32:35], v[120:123]
    v_mfma_f32_16x16x32_bf16 v[124:127], v[252:255], v[36:39], v[124:127]
    v_add_u32 v10, s78, v5
    s_add_u32 s78, s78, 0x800
    s_and_b32 s78, s78, 0x7fff
    ds_read_b128 v[32:35], v10 offset:0
    ds_read_b128 v[36:39], v10 offset:1024
    v_perm_b32 v252, v199, v195, s57
    v_perm_b32 v253, v207, v203, s57
    v_perm_b32 v254, v215, v211, s57
    v_perm_b32 v255, v223, v219, s57
    buffer_load_dwordx4 v[188:191], v4, s[48:51], s68 offen offset:3072
    s_add_u32 s79, s79, 0x8000
    s_and_b32 s79, s79, 0x7ffff
    s_or_b32 s68, s79, s77
    s_waitcnt lgkmcnt(3)
    v_mfma_f32_16x16x32_bf16 v[64:67], v[224:227], v[40:43], v[64:67]
    s_waitcnt lgkmcnt(2)
    v_mfma_f32_16x16x32_bf16 v[68:71], v[224:227], v[44:47], v[68:71]
    s_waitcnt vmcnt(14)
    v_perm_b32 v224, v132, v128, s56
    s_waitcnt vmcnt(12)
    v_perm_b32 v225, v140, v136, s56
    s_waitcnt vmcnt(10)
    v_perm_b32 v226, v148, v144, s56
    s_waitcnt vmcnt(8)
    v_perm_b32 v227, v156, v152, s56
    buffer_load_dwordx4 v[192:195], v3, s[48:51], s68 offen
    v_mfma_f32_16x16x32_bf16 v[72:75], v[228:231], v[40:43], v[72:75]
    v_mfma_f32_16x16x32_bf16 v[76:79], v[228:231], v[44:47], v[76:79]
    v_perm_b32 v228, v132, v128, s57
    v_perm_b32 v229, v140, v136, s57
    v_perm_b32 v230, v148, v144, s57
    v_perm_b32 v231, v156, v152, s57
    buffer_load_dwordx4 v[196:199], v3, s[48:51], s68 offen offset:1024
    v_mfma_f32_16x16x32_bf16 v[80:83], v[232:235], v[40:43], v[80:83]
    v_mfma_f32_16x16x32_bf16 v[84:87], v[232:235], v[44:47], v[84:87]
    v_perm_b32 v232, v133, v129, s56
    v_perm_b32 v233, v141, v137, s56
    v_perm_b32 v234, v149, v145, s56
    v_perm_b32 v235, v157, v153, s56
    buffer_load_dwordx4 v[200:203], v3, s[48:51], s68 offen offset:2048
    v_mfma_f32_16x16x32_bf16 v[88:91], v[236:239], v[40:43], v[88:91]
    v_mfma_f32_16x16x32_bf16 v[92:95], v[236:239], v[44:47], v[92:95]
    v_perm_b32 v236, v133, v129, s57
    v_perm_b32 v237, v141, v137, s57
    v_perm_b32 v238, v149, v145, s57
    v_perm_b32 v239, v157, v153, s57
    buffer_load_dwordx4 v[204:207], v3, s[48:51], s68 offen offset:3072
    v_mfma_f32_16x16x32_bf16 v[96:99], v[240:243], v[40:43], v[96:99]
    v_mfma_f32_16x16x32_bf16 v[100:103], v[240:243], v[44:47], v[100:103]
    v_perm_b32 v240, v134, v130, s56
    v_perm_b32 v241, v142, v138, s56
    v_perm_b32 v242, v150, v146, s56
    v_perm_b32 v243, v158, v154, s56
    buffer_load_dwordx4 v[208:211], v4, s[48:51], s68 offen
    v_mfma_f32_16x16x32_bf16 v[104:107], v[244:247], v[40:43], v[104:107]
    v_mfma_f32_16x16x32_bf16 v[108:111], v[244:247], v[44:47], v[108:111]
    v_perm_b32 v244, v134, v130, s57
    v_perm_b32 v245, v142, v138, s57
    v_perm_b32 v246, v150, v146, s57
    v_perm_b32 v247, v158, v154, s57
    buffer_load_dwordx4 v[212:215], v4, s[48:51], s68 offen offset:1024
    v_mfma_f32_16x16x32_bf16 v[112:115], v[248:251], v[40:43], v[112:115]
    v_mfma_f32_16x16x32_bf16 v[116:119], v[248:251], v[44:47], v[116:119]
    v_perm_b32 v248, v135, v131, s56
    v_perm_b32 v249, v143, v139, s56
    v_perm_b32 v250, v151, v147, s56
    v_perm_b32 v251, v159, v155, s56
    buffer_load_dwordx4 v[216:219], v4, s[48:51], s68 offen offset:2048
    v_mfma_f32_16x16x32_bf16 v[120:123], v[252:255], v[40:43], v[120:123]
    v_mfma_f32_16x16x32_bf16 v[124:127], v[252:255], v[44:47], v[124:127]
    v_add_u32 v15, s78, v5
    s_add_u32 s78, s78, 0x800
    s_and_b32 s78, s78, 0x7fff
    ds_read_b128 v[40:43], v15 offset:0
    ds_read_b128 v[44:47], v15 offset:1024
    v_perm_b32 v252, v135, v131, s57
    v_perm_b32 v253, v143, v139, s57
    v_perm_b32 v254, v151, v147, s57
    v_perm_b32 v255, v159, v155, s57
    buffer_load_dwordx4 v[220:223], v4, s[48:51], s68 offen offset:3072
    s_add_u32 s79, s79, 0x8000
    s_and_b32 s79, s79, 0x7ffff
    s_or_b32 s68, s79, s77
    s_waitcnt lgkmcnt(3)
    v_mfma_f32_16x16x32_bf16 v[64:67], v[224:227], v[32:35], v[64:67]
    s_waitcnt lgkmcnt(2)
    v_mfma_f32_16x16x32_bf16 v[68:71], v[224:227], v[36:39], v[68:71]
    s_waitcnt vmcnt(14)
    v_perm_b32 v224, v164, v160, s56
    s_waitcnt vmcnt(12)
    v_perm_b32 v225, v172, v168, s56
    s_waitcnt vmcnt(10)
    v_perm_b32 v226, v180, v176, s56
    s_waitcnt vmcnt(8)
    v_perm_b32 v227, v188, v184, s56
    buffer_load_dwordx4 v[128:131], v3, s[48:51], s68 offen
    v_mfma_f32_16x16x32_bf16 v[72:75], v[228:231], v[32:35], v[72:75]
    v_mfma_f32_16x16x32_bf16 v[76:79], v[228:231], v[36:39], v[76:79]
    v_perm_b32 v228, v164, v160, s57
    v_perm_b32 v229, v172, v168, s57
    v_perm_b32 v230, v180, v176, s57
    v_perm_b32 v231, v188, v184, s57
    buffer_load_dwordx4 v[132:135], v3, s[48:51], s68 offen offset:1024
    v_mfma_f32_16x16x32_bf16 v[80:83], v[232:235], v[32:35], v[80:83]
    v_mfma_f32_16x16x32_bf16 v[84:87], v[232:235], v[36:39], v[84:87]
    v_perm_b32 v232, v165, v161, s56
    v_perm_b32 v233, v173, v169, s56
    v_perm_b32 v234, v181, v177, s56
    v_perm_b32 v235, v189, v185, s56
    buffer_load_dwordx4 v[136:139], v3, s[48:51], s68 offen offset:2048
    v_mfma_f32_16x16x32_bf16 v[88:91], v[236:239], v[32:35], v[88:91]
    v_mfma_f32_16x16x32_bf16 v[92:95], v[236:239], v[36:39], v[92:95]
    v_perm_b32 v236, v165, v161, s57
    v_perm_b32 v237, v173, v169, s57
    v_perm_b32 v238, v181, v177, s57
    v_perm_b32 v239, v189, v185, s57
    buffer_load_dwordx4 v[140:143], v3, s[48:51], s68 offen offset:3072
    v_mfma_f32_16x16x32_bf16 v[96:99], v[240:243], v[32:35], v[96:99]
    v_mfma_f32_16x16x32_bf16 v[100:103], v[240:243], v[36:39], v[100:103]
    v_perm_b32 v240, v166, v162, s56
    v_perm_b32 v241, v174, v170, s56
    v_perm_b32 v242, v182, v178, s56
    v_perm_b32 v243, v190, v186, s56
    buffer_load_dwordx4 v[144:147], v4, s[48:51], s68 offen
    v_mfma_f32_16x16x32_bf16 v[104:107], v[244:247], v[32:35], v[104:107]
    v_mfma_f32_16x16x32_bf16 v[108:111], v[244:247], v[36:39], v[108:111]
    v_perm_b32 v244, v166, v162, s57
    v_perm_b32 v245, v174, v170, s57
    v_perm_b32 v246, v182, v178, s57
    v_perm_b32 v247, v190, v186, s57
    buffer_load_dwordx4 v[148:151], v4, s[48:51], s68 offen offset:1024
    v_mfma_f32_16x16x32_bf16 v[112:115], v[248:251], v[32:35], v[112:115]
    v_mfma_f32_16x16x32_bf16 v[116:119], v[248:251], v[36:39], v[116:119]
    v_perm_b32 v248, v167, v163, s56
    v_perm_b32 v249, v175, v171, s56
    v_perm_b32 v250, v183, v179, s56
    v_perm_b32 v251, v191, v187, s56
    buffer_load_dwordx4 v[152:155], v4, s[48:51], s68 offen offset:2048
    v_mfma_f32_16x16x32_bf16 v[120:123], v[252:255], v[32:35], v[120:123]
    v_mfma_f32_16x16x32_bf16 v[124:127], v[252:255], v[36:39], v[124:127]
    v_add_u32 v10, s78, v5
    s_add_u32 s78, s78, 0x800
    s_and_b32 s78, s78, 0x7fff
    ds_read_b128 v[32:35], v10 offset:0
    ds_read_b128 v[36:39], v10 offset:1024
    v_perm_b32 v252, v167, v163, s57
    v_perm_b32 v253, v175, v171, s57
    v_perm_b32 v254, v183, v179, s57
    v_perm_b32 v255, v191, v187, s57
    buffer_load_dwordx4 v[156:159], v4, s[48:51], s68 offen offset:3072
    s_add_u32 s79, s79, 0x8000
    s_and_b32 s79, s79, 0x7ffff
    s_or_b32 s68, s79, s77
    s_waitcnt lgkmcnt(3)
    v_mfma_f32_16x16x32_bf16 v[64:67], v[224:227], v[40:43], v[64:67]
    s_waitcnt lgkmcnt(2)
    v_mfma_f32_16x16x32_bf16 v[68:71], v[224:227], v[44:47], v[68:71]
    s_waitcnt vmcnt(14)
    v_perm_b32 v224, v196, v192, s56
    s_waitcnt vmcnt(12)
    v_perm_b32 v225, v204, v200, s56
    s_waitcnt vmcnt(10)
    v_perm_b32 v226, v212, v208, s56
    s_waitcnt vmcnt(8)
    v_perm_b32 v227, v220, v216, s56
    buffer_load_dwordx4 v[160:163], v3, s[48:51], s68 offen
    v_mfma_f32_16x16x32_bf16 v[72:75], v[228:231], v[40:43], v[72:75]
    v_mfma_f32_16x16x32_bf16 v[76:79], v[228:231], v[44:47], v[76:79]
    v_perm_b32 v228, v196, v192, s57
    v_perm_b32 v229, v204, v200, s57
    v_perm_b32 v230, v212, v208, s57
    v_perm_b32 v231, v220, v216, s57
    buffer_load_dwordx4 v[164:167], v3, s[48:51], s68 offen offset:1024
    v_mfma_f32_16x16x32_bf16 v[80:83], v[232:235], v[40:43], v[80:83]
    v_mfma_f32_16x16x32_bf16 v[84:87], v[232:235], v[44:47], v[84:87]
    v_perm_b32 v232, v197, v193, s56
    v_perm_b32 v233, v205, v201, s56
    v_perm_b32 v234, v213, v209, s56
    v_perm_b32 v235, v221, v217, s56
    buffer_load_dwordx4 v[168:171], v3, s[48:51], s68 offen offset:2048
    v_mfma_f32_16x16x32_bf16 v[88:91], v[236:239], v[40:43], v[88:91]
    v_mfma_f32_16x16x32_bf16 v[92:95], v[236:239], v[44:47], v[92:95]
    v_perm_b32 v236, v197, v193, s57
    v_perm_b32 v237, v205, v201, s57
    v_perm_b32 v238, v213, v209, s57
    v_perm_b32 v239, v221, v217, s57
    buffer_load_dwordx4 v[172:175], v3, s[48:51], s68 offen offset:3072
    v_mfma_f32_16x16x32_bf16 v[96:99], v[240:243], v[40:43], v[96:99]
    v_mfma_f32_16x16x32_bf16 v[100:103], v[240:243], v[44:47], v[100:103]
    v_perm_b32 v240, v198, v194, s56
    v_perm_b32 v241, v206, v202, s56
    v_perm_b32 v242, v214, v210, s56
    v_perm_b32 v243, v222, v218, s56
    buffer_load_dwordx4 v[176:179], v4, s[48:51], s68 offen
    v_mfma_f32_16x16x32_bf16 v[104:107], v[244:247], v[40:43], v[104:107]
    v_mfma_f32_16x16x32_bf16 v[108:111], v[244:247], v[44:47], v[108:111]
    v_perm_b32 v244, v198, v194, s57
    v_perm_b32 v245, v206, v202, s57
    v_perm_b32 v246, v214, v210, s57
    v_perm_b32 v247, v222, v218, s57
    buffer_load_dwordx4 v[180:183], v4, s[48:51], s68 offen offset:1024
    v_mfma_f32_16x16x32_bf16 v[112:115], v[248:251], v[40:43], v[112:115]
    v_mfma_f32_16x16x32_bf16 v[116:119], v[248:251], v[44:47], v[116:119]
    v_perm_b32 v248, v199, v195, s56
    v_perm_b32 v249, v207, v203, s56
    v_perm_b32 v250, v215, v211, s56
    v_perm_b32 v251, v223, v219, s56
    buffer_load_dwordx4 v[184:187], v4, s[48:51], s68 offen offset:2048
    v_mfma_f32_16x16x32_bf16 v[120:123], v[252:255], v[40:43], v[120:123]
    v_mfma_f32_16x16x32_bf16 v[124:127], v[252:255], v[44:47], v[124:127]
    v_add_u32 v15, s78, v5
    s_add_u32 s78, s78, 0x800
    s_and_b32 s78, s78, 0x7fff
    ds_read_b128 v[40:43], v15 offset:0
    ds_read_b128 v[44:47], v15 offset:1024
    v_perm_b32 v252, v199, v195, s57
    v_perm_b32 v253, v207, v203, s57
    v_perm_b32 v254, v215, v211, s57
    v_perm_b32 v255, v223, v219, s57
    buffer_load_dwordx4 v[188:191], v4, s[48:51], s68 offen offset:3072
    s_add_u32 s79, s79, 0x8000
    s_and_b32 s79, s79, 0x7ffff
    s_or_b32 s68, s79, s77
    s_waitcnt lgkmcnt(3)
    v_mfma_f32_16x16x32_bf16 v[64:67], v[224:227], v[32:35], v[64:67]
    s_waitcnt lgkmcnt(2)
    v_mfma_f32_16x16x32_bf16 v[68:71], v[224:227], v[36:39], v[68:71]
    s_waitcnt vmcnt(14)
    v_perm_b32 v224, v132, v128, s56
    s_waitcnt vmcnt(12)
    v_perm_b32 v225, v140, v136, s56
    s_waitcnt vmcnt(10)
    v_perm_b32 v226, v148, v144, s56
    s_waitcnt vmcnt(8)
    v_perm_b32 v227, v156, v152, s56
    buffer_load_dwordx4 v[192:195], v3, s[48:51], s68 offen
    v_mfma_f32_16x16x32_bf16 v[72:75], v[228:231], v[32:35], v[72:75]
    v_mfma_f32_16x16x32_bf16 v[76:79], v[228:231], v[36:39], v[76:79]
    v_perm_b32 v228, v132, v128, s57
    v_perm_b32 v229, v140, v136, s57
    v_perm_b32 v230, v148, v144, s57
    v_perm_b32 v231, v156, v152, s57
    buffer_load_dwordx4 v[196:199], v3, s[48:51], s68 offen offset:1024
    v_mfma_f32_16x16x32_bf16 v[80:83], v[232:235], v[32:35], v[80:83]
    v_mfma_f32_16x16x32_bf16 v[84:87], v[232:235], v[36:39], v[84:87]
    v_perm_b32 v232, v133, v129, s56
    v_perm_b32 v233, v141, v137, s56
    v_perm_b32 v234, v149, v145, s56
    v_perm_b32 v235, v157, v153, s56
    buffer_load_dwordx4 v[200:203], v3, s[48:51], s68 offen offset:2048
    v_mfma_f32_16x16x32_bf16 v[88:91], v[236:239], v[32:35], v[88:91]
    v_mfma_f32_16x16x32_bf16 v[92:95], v[236:239], v[36:39], v[92:95]
    v_perm_b32 v236, v133, v129, s57
    v_perm_b32 v237, v141, v137, s57
    v_perm_b32 v238, v149, v145, s57
    v_perm_b32 v239, v157, v153, s57
    buffer_load_dwordx4 v[204:207], v3, s[48:51], s68 offen offset:3072
    v_mfma_f32_16x16x32_bf16 v[96:99], v[240:243], v[32:35], v[96:99]
    v_mfma_f32_16x16x32_bf16 v[100:103], v[240:243], v[36:39], v[100:103]
    v_perm_b32 v240, v134, v130, s56
    v_perm_b32 v241, v142, v138, s56
    v_perm_b32 v242, v150, v146, s56
    v_perm_b32 v243, v158, v154, s56
    buffer_load_dwordx4 v[208:211], v4, s[48:51], s68 offen
    v_mfma_f32_16x16x32_bf16 v[104:107], v[244:247], v[32:35], v[104:107]
    v_mfma_f32_16x16x32_bf16 v[108:111], v[244:247], v[36:39], v[108:111]
    v_perm_b32 v244, v134, v130, s57
    v_perm_b32 v245, v142, v138, s57
    v_perm_b32 v246, v150, v146, s57
    v_perm_b32 v247, v158, v154, s57
    buffer_load_dwordx4 v[212:215], v4, s[48:51], s68 offen offset:1024
    v_mfma_f32_16x16x32_bf16 v[112:115], v[248:251], v[32:35], v[112:115]
    v_mfma_f32_16x16x32_bf16 v[116:119], v[248:251], v[36:39], v[116:119]
    v_perm_b32 v248, v135, v131, s56
    v_perm_b32 v249, v143, v139, s56
    v_perm_b32 v250, v151, v147, s56
    v_perm_b32 v251, v159, v155, s56
    buffer_load_dwordx4 v[216:219], v4, s[48:51], s68 offen offset:2048
    v_mfma_f32_16x16x32_bf16 v[120:123], v[252:255], v[32:35], v[120:123]
    v_mfma_f32_16x16x32_bf16 v[124:127], v[252:255], v[36:39], v[124:127]
    v_add_u32 v10, s78, v5
    s_add_u32 s78, s78, 0x800
    s_and_b32 s78, s78, 0x7fff
    ds_read_b128 v[32:35], v10 offset:0
    ds_read_b128 v[36:39], v10 offset:1024
    v_perm_b32 v252, v135, v131, s57
    v_perm_b32 v253, v143, v139, s57
    v_perm_b32 v254, v151, v147, s57
    v_perm_b32 v255, v159, v155, s57
    buffer_load_dwordx4 v[220:223], v4, s[48:51], s68 offen offset:3072
    s_add_u32 s79, s79, 0x8000
    s_and_b32 s79, s79, 0x7ffff
    s_or_b32 s68, s79, s77
    s_waitcnt lgkmcnt(3)
    v_mfma_f32_16x16x32_bf16 v[64:67], v[224:227], v[40:43], v[64:67]
    s_waitcnt lgkmcnt(2)
    v_mfma_f32_16x16x32_bf16 v[68:71], v[224:227], v[44:47], v[68:71]
    s_waitcnt vmcnt(14)
    v_perm_b32 v224, v164, v160, s56
    s_waitcnt vmcnt(12)
    v_perm_b32 v225, v172, v168, s56
    s_waitcnt vmcnt(10)
    v_perm_b32 v226, v180, v176, s56
    s_waitcnt vmcnt(8)
    v_perm_b32 v227, v188, v184, s56
    buffer_load_dwordx4 v[128:131], v3, s[48:51], s68 offen
    v_mfma_f32_16x16x32_bf16 v[72:75], v[228:231], v[40:43], v[72:75]
    v_mfma_f32_16x16x32_bf16 v[76:79], v[228:231], v[44:47], v[76:79]
    v_perm_b32 v228, v164, v160, s57
    v_perm_b32 v229, v172, v168, s57
    v_perm_b32 v230, v180, v176, s57
    v_perm_b32 v231, v188, v184, s57
    buffer_load_dwordx4 v[132:135], v3, s[48:51], s68 offen offset:1024
    v_mfma_f32_16x16x32_bf16 v[80:83], v[232:235], v[40:43], v[80:83]
    v_mfma_f32_16x16x32_bf16 v[84:87], v[232:235], v[44:47], v[84:87]
    v_perm_b32 v232, v165, v161, s56
    v_perm_b32 v233, v173, v169, s56
    v_perm_b32 v234, v181, v177, s56
    v_perm_b32 v235, v189, v185, s56
    buffer_load_dwordx4 v[136:139], v3, s[48:51], s68 offen offset:2048
    v_mfma_f32_16x16x32_bf16 v[88:91], v[236:239], v[40:43], v[88:91]
    v_mfma_f32_16x16x32_bf16 v[92:95], v[236:239], v[44:47], v[92:95]
    v_perm_b32 v236, v165, v161, s57
    v_perm_b32 v237, v173, v169, s57
    v_perm_b32 v238, v181, v177, s57
    v_perm_b32 v239, v189, v185, s57
    buffer_load_dwordx4 v[140:143], v3, s[48:51], s68 offen offset:3072
    v_mfma_f32_16x16x32_bf16 v[96:99], v[240:243], v[40:43], v[96:99]
    v_mfma_f32_16x16x32_bf16 v[100:103], v[240:243], v[44:47], v[100:103]
    v_perm_b32 v240, v166, v162, s56
    v_perm_b32 v241, v174, v170, s56
    v_perm_b32 v242, v182, v178, s56
    v_perm_b32 v243, v190, v186, s56
    buffer_load_dwordx4 v[144:147], v4, s[48:51], s68 offen
    v_mfma_f32_16x16x32_bf16 v[104:107], v[244:247], v[40:43], v[104:107]
    v_mfma_f32_16x16x32_bf16 v[108:111], v[244:247], v[44:47], v[108:111]
    v_perm_b32 v244, v166, v162, s57
    v_perm_b32 v245, v174, v170, s57
    v_perm_b32 v246, v182, v178, s57
    v_perm_b32 v247, v190, v186, s57
    buffer_load_dwordx4 v[148:151], v4, s[48:51], s68 offen offset:1024
    v_mfma_f32_16x16x32_bf16 v[112:115], v[248:251], v[40:43], v[112:115]
    v_mfma_f32_16x16x32_bf16 v[116:119], v[248:251], v[44:47], v[116:119]
    v_perm_b32 v248, v167, v163, s56
    v_perm_b32 v249, v175, v171, s56
    v_perm_b32 v250, v183, v179, s56
    v_perm_b32 v251, v191, v187, s56
    buffer_load_dwordx4 v[152:155], v4, s[48:51], s68 offen offset:2048
    v_mfma_f32_16x16x32_bf16 v[120:123], v[252:255], v[40:43], v[120:123]
    v_mfma_f32_16x16x32_bf16 v[124:127], v[252:255], v[44:47], v[124:127]
    v_add_u32 v15, s78, v5
    s_add_u32 s78, s78, 0x800
    s_and_b32 s78, s78, 0x7fff
    ds_read_b128 v[40:43], v15 offset:0
    ds_read_b128 v[44:47], v15 offset:1024
    v_perm_b32 v252, v167, v163, s57
    v_perm_b32 v253, v175, v171, s57
    v_perm_b32 v254, v183, v179, s57
    v_perm_b32 v255, v191, v187, s57
    buffer_load_dwordx4 v[156:159], v4, s[48:51], s68 offen offset:3072
    s_add_u32 s79, s79, 0x8000
    s_and_b32 s79, s79, 0x7ffff
    s_or_b32 s68, s79, s77
    s_waitcnt lgkmcnt(3)
    v_mfma_f32_16x16x32_bf16 v[64:67], v[224:227], v[32:35], v[64:67]
    s_waitcnt lgkmcnt(2)
    v_mfma_f32_16x16x32_bf16 v[68:71], v[224:227], v[36:39], v[68:71]
    s_waitcnt vmcnt(14)
    v_perm_b32 v224, v196, v192, s56
    s_waitcnt vmcnt(12)
    v_perm_b32 v225, v204, v200, s56
    s_waitcnt vmcnt(10)
    v_perm_b32 v226, v212, v208, s56
    s_waitcnt vmcnt(8)
    v_perm_b32 v227, v220, v216, s56
    v_add_u32 v6, s60, v13
    ds_read_b128 v[160:163], v6 offset:0
    v_mfma_f32_16x16x32_bf16 v[72:75], v[228:231], v[32:35], v[72:75]
    v_mfma_f32_16x16x32_bf16 v[76:79], v[228:231], v[36:39], v[76:79]
    v_perm_b32 v228, v196, v192, s57
    v_perm_b32 v229, v204, v200, s57
    v_perm_b32 v230, v212, v208, s57
    v_perm_b32 v231, v220, v216, s57
    ds_read_b128 v[164:167], v6 offset:1024
    v_mfma_f32_16x16x32_bf16 v[80:83], v[232:235], v[32:35], v[80:83]
    v_mfma_f32_16x16x32_bf16 v[84:87], v[232:235], v[36:39], v[84:87]
    v_perm_b32 v232, v197, v193, s56
    v_perm_b32 v233, v205, v201, s56
    v_perm_b32 v234, v213, v209, s56
    v_perm_b32 v235, v221, v217, s56
    ds_read_b128 v[168:171], v6 offset:2048
    v_mfma_f32_16x16x32_bf16 v[88:91], v[236:239], v[32:35], v[88:91]
    v_mfma_f32_16x16x32_bf16 v[92:95], v[236:239], v[36:39], v[92:95]
    v_perm_b32 v236, v197, v193, s57
    v_perm_b32 v237, v205, v201, s57
    v_perm_b32 v238, v213, v209, s57
    v_perm_b32 v239, v221, v217, s57
    ds_read_b128 v[172:175], v6 offset:3072
    v_mfma_f32_16x16x32_bf16 v[96:99], v[240:243], v[32:35], v[96:99]
    v_mfma_f32_16x16x32_bf16 v[100:103], v[240:243], v[36:39], v[100:103]
    v_perm_b32 v240, v198, v194, s56
    v_perm_b32 v241, v206, v202, s56
    v_perm_b32 v242, v214, v210, s56
    v_perm_b32 v243, v222, v218, s56
    ds_read_b128 v[176:179], v6 offset:4096
    v_mfma_f32_16x16x32_bf16 v[104:107], v[244:247], v[32:35], v[104:107]
    v_mfma_f32_16x16x32_bf16 v[108:111], v[244:247], v[36:39], v[108:111]
    v_perm_b32 v244, v198, v194, s57
    v_perm_b32 v245, v206, v202, s57
    v_perm_b32 v246, v214, v210, s57
    v_perm_b32 v247, v222, v218, s57
    ds_read_b128 v[180:183], v6 offset:5120
    v_mfma_f32_16x16x32_bf16 v[112:115], v[248:251], v[32:35], v[112:115]
    v_mfma_f32_16x16x32_bf16 v[116:119], v[248:251], v[36:39], v[116:119]
    v_perm_b32 v248, v199, v195, s56
    v_perm_b32 v249, v207, v203, s56
    v_perm_b32 v250, v215, v211, s56
    v_perm_b32 v251, v223, v219, s56
    ds_read_b128 v[184:187], v6 offset:6144
    v_mfma_f32_16x16x32_bf16 v[120:123], v[252:255], v[32:35], v[120:123]
    v_mfma_f32_16x16x32_bf16 v[124:127], v[252:255], v[36:39], v[124:127]
    v_add_u32 v10, s78, v5
    s_add_u32 s78, s78, 0x800
    s_and_b32 s78, s78, 0x7fff
    ds_read_b128 v[32:35], v10 offset:0
    ds_read_b128 v[36:39], v10 offset:1024
    v_perm_b32 v252, v199, v195, s57
    v_perm_b32 v253, v207, v203, s57
    v_perm_b32 v254, v215, v211, s57
    v_perm_b32 v255, v223, v219, s57
    ds_read_b128 v[188:191], v6 offset:7168
    s_waitcnt lgkmcnt(11)
    v_mfma_f32_16x16x32_bf16 v[64:67], v[224:227], v[40:43], v[64:67]
    s_waitcnt lgkmcnt(10)
    v_mfma_f32_16x16x32_bf16 v[68:71], v[224:227], v[44:47], v[68:71]
    s_waitcnt vmcnt(6)
    v_perm_b32 v224, v132, v128, s56
    s_waitcnt vmcnt(4)
    v_perm_b32 v225, v140, v136, s56
    s_waitcnt vmcnt(2)
    v_perm_b32 v226, v148, v144, s56
    s_waitcnt vmcnt(0)
    v_perm_b32 v227, v156, v152, s56
    v_add_u32 v6, s61, v13
    ds_read_b128 v[192:195], v6 offset:0
    v_mfma_f32_16x16x32_bf16 v[72:75], v[228:231], v[40:43], v[72:75]
    v_mfma_f32_16x16x32_bf16 v[76:79], v[228:231], v[44:47], v[76:79]
    v_perm_b32 v228, v132, v128, s57
    v_perm_b32 v229, v140, v136, s57
    v_perm_b32 v230, v148, v144, s57
    v_perm_b32 v231, v156, v152, s57
    ds_read_b128 v[196:199], v6 offset:1024
    v_mfma_f32_16x16x32_bf16 v[80:83], v[232:235], v[40:43], v[80:83]
    v_mfma_f32_16x16x32_bf16 v[84:87], v[232:235], v[44:47], v[84:87]
    v_perm_b32 v232, v133, v129, s56
    v_perm_b32 v233, v141, v137, s56
    v_perm_b32 v234, v149, v145, s56
    v_perm_b32 v235, v157, v153, s56
    ds_read_b128 v[200:203], v6 offset:2048
    v_mfma_f32_16x16x32_bf16 v[88:91], v[236:239], v[40:43], v[88:91]
    v_mfma_f32_16x16x32_bf16 v[92:95], v[236:239], v[44:47], v[92:95]
    v_perm_b32 v236, v133, v129, s57
    v_perm_b32 v237, v141, v137, s57
    v_perm_b32 v238, v149, v145, s57
    v_perm_b32 v239, v157, v153, s57
    ds_read_b128 v[204:207], v6 offset:3072
    v_mfma_f32_16x16x32_bf16 v[96:99], v[240:243], v[40:43], v[96:99]
    v_mfma_f32_16x16x32_bf16 v[100:103], v[240:243], v[44:47], v[100:103]
    v_perm_b32 v240, v134, v130, s56
    v_perm_b32 v241, v142, v138, s56
    v_perm_b32 v242, v150, v146, s56
    v_perm_b32 v243, v158, v154, s56
    ds_read_b128 v[208:211], v6 offset:4096
    v_mfma_f32_16x16x32_bf16 v[104:107], v[244:247], v[40:43], v[104:107]
    v_mfma_f32_16x16x32_bf16 v[108:111], v[244:247], v[44:47], v[108:111]
    v_perm_b32 v244, v134, v130, s57
    v_perm_b32 v245, v142, v138, s57
    v_perm_b32 v246, v150, v146, s57
    v_perm_b32 v247, v158, v154, s57
    s_waitcnt lgkmcnt(14)
    ds_read_b128 v[212:215], v6 offset:5120
    v_mfma_f32_16x16x32_bf16 v[112:115], v[248:251], v[40:43], v[112:115]
    v_mfma_f32_16x16x32_bf16 v[116:119], v[248:251], v[44:47], v[116:119]
    v_perm_b32 v248, v135, v131, s56
    v_perm_b32 v249, v143, v139, s56
    v_perm_b32 v250, v151, v147, s56
    v_perm_b32 v251, v159, v155, s56
    s_waitcnt lgkmcnt(14)
    ds_read_b128 v[216:219], v6 offset:6144
    v_mfma_f32_16x16x32_bf16 v[120:123], v[252:255], v[40:43], v[120:123]
    v_mfma_f32_16x16x32_bf16 v[124:127], v[252:255], v[44:47], v[124:127]
    v_add_u32 v15, s78, v5
    s_add_u32 s78, s78, 0x800
    s_and_b32 s78, s78, 0x7fff
    s_waitcnt lgkmcnt(14)
    ds_read_b128 v[40:43], v15 offset:0
    s_waitcnt lgkmcnt(14)
    ds_read_b128 v[44:47], v15 offset:1024
    v_perm_b32 v252, v135, v131, s57
    v_perm_b32 v253, v143, v139, s57
    v_perm_b32 v254, v151, v147, s57
    v_perm_b32 v255, v159, v155, s57
    s_waitcnt lgkmcnt(14)
    ds_read_b128 v[220:223], v6 offset:7168
    s_waitcnt lgkmcnt(12)
    v_mfma_f32_16x16x32_bf16 v[64:67], v[224:227], v[32:35], v[64:67]
    s_waitcnt lgkmcnt(11)
    v_mfma_f32_16x16x32_bf16 v[68:71], v[224:227], v[36:39], v[68:71]
    v_perm_b32 v224, v164, v160, s56
    v_perm_b32 v225, v172, v168, s56
    v_perm_b32 v226, v180, v176, s56
    s_waitcnt lgkmcnt(10)
    v_perm_b32 v227, v188, v184, s56
    v_add_u32 v6, s62, v13
    ds_read_b128 v[128:131], v6 offset:0
    v_mfma_f32_16x16x32_bf16 v[72:75], v[228:231], v[32:35], v[72:75]
    v_mfma_f32_16x16x32_bf16 v[76:79], v[228:231], v[36:39], v[76:79]
    v_perm_b32 v228, v164, v160, s57
    v_perm_b32 v229, v172, v168, s57
    v_perm_b32 v230, v180, v176, s57
    v_perm_b32 v231, v188, v184, s57
    ds_read_b128 v[132:135], v6 offset:1024
    v_mfma_f32_16x16x32_bf16 v[80:83], v[232:235], v[32:35], v[80:83]
    v_mfma_f32_16x16x32_bf16 v[84:87], v[232:235], v[36:39], v[84:87]
    v_perm_b32 v232, v165, v161, s56
    v_perm_b32 v233, v173, v169, s56
    v_perm_b32 v234, v181, v177, s56
    v_perm_b32 v235, v189, v185, s56
    ds_read_b128 v[136:139], v6 offset:2048
    v_mfma_f32_16x16x32_bf16 v[88:91], v[236:239], v[32:35], v[88:91]
    v_mfma_f32_16x16x32_bf16 v[92:95], v[236:239], v[36:39], v[92:95]
    v_perm_b32 v236, v165, v161, s57
    v_perm_b32 v237, v173, v169, s57
    v_perm_b32 v238, v181, v177, s57
    v_perm_b32 v239, v189, v185, s57
    ds_read_b128 v[140:143], v6 offset:3072
    v_mfma_f32_16x16x32_bf16 v[96:99], v[240:243], v[32:35], v[96:99]
    v_mfma_f32_16x16x32_bf16 v[100:103], v[240:243], v[36:39], v[100:103]
    v_perm_b32 v240, v166, v162, s56
    v_perm_b32 v241, v174, v170, s56
    v_perm_b32 v242, v182, v178, s56
    v_perm_b32 v243, v190, v186, s56
    ds_read_b128 v[144:147], v6 offset:4096
    v_mfma_f32_16x16x32_bf16 v[104:107], v[244:247], v[32:35], v[104:107]
    v_mfma_f32_16x16x32_bf16 v[108:111], v[244:247], v[36:39], v[108:111]
    v_perm_b32 v244, v166, v162, s57
    v_perm_b32 v245, v174, v170, s57
    v_perm_b32 v246, v182, v178, s57
    v_perm_b32 v247, v190, v186, s57
    s_waitcnt lgkmcnt(14)
    ds_read_b128 v[148:151], v6 offset:5120
    v_mfma_f32_16x16x32_bf16 v[112:115], v[248:251], v[32:35], v[112:115]
    v_mfma_f32_16x16x32_bf16 v[116:119], v[248:251], v[36:39], v[116:119]
    v_perm_b32 v248, v167, v163, s56
    v_perm_b32 v249, v175, v171, s56
    v_perm_b32 v250, v183, v179, s56
    v_perm_b32 v251, v191, v187, s56
    s_waitcnt lgkmcnt(14)
    ds_read_b128 v[152:155], v6 offset:6144
    v_mfma_f32_16x16x32_bf16 v[120:123], v[252:255], v[32:35], v[120:123]
    v_mfma_f32_16x16x32_bf16 v[124:127], v[252:255], v[36:39], v[124:127]
    v_add_u32 v10, s78, v5
    s_add_u32 s78, s78, 0x800
    s_and_b32 s78, s78, 0x7fff
    s_waitcnt lgkmcnt(14)
    ds_read_b128 v[32:35], v10 offset:0
    s_waitcnt lgkmcnt(14)
    ds_read_b128 v[36:39], v10 offset:1024
    v_perm_b32 v252, v167, v163, s57
    v_perm_b32 v253, v175, v171, s57
    v_perm_b32 v254, v183, v179, s57
    v_perm_b32 v255, v191, v187, s57
    s_waitcnt lgkmcnt(14)
    ds_read_b128 v[156:159], v6 offset:7168
    s_waitcnt lgkmcnt(12)
    v_mfma_f32_16x16x32_bf16 v[64:67], v[224:227], v[40:43], v[64:67]
    s_waitcnt lgkmcnt(11)
    v_mfma_f32_16x16x32_bf16 v[68:71], v[224:227], v[44:47], v[68:71]
    v_perm_b32 v224, v196, v192, s56
    v_perm_b32 v225, v204, v200, s56
    v_perm_b32 v226, v212, v208, s56
    s_waitcnt lgkmcnt(10)
    v_perm_b32 v227, v220, v216, s56
    v_mfma_f32_16x16x32_bf16 v[72:75], v[228:231], v[40:43], v[72:75]
    v_mfma_f32_16x16x32_bf16 v[76:79], v[228:231], v[44:47], v[76:79]
    v_perm_b32 v228, v196, v192, s57
    v_perm_b32 v229, v204, v200, s57
    v_perm_b32 v230, v212, v208, s57
    v_perm_b32 v231, v220, v216, s57
    v_mfma_f32_16x16x32_bf16 v[80:83], v[232:235], v[40:43], v[80:83]
    v_mfma_f32_16x16x32_bf16 v[84:87], v[232:235], v[44:47], v[84:87]
    v_perm_b32 v232, v197, v193, s56
    v_perm_b32 v233, v205, v201, s56
    v_perm_b32 v234, v213, v209, s56
    v_perm_b32 v235, v221, v217, s56
    v_mfma_f32_16x16x32_bf16 v[88:91], v[236:239], v[40:43], v[88:91]
    v_mfma_f32_16x16x32_bf16 v[92:95], v[236:239], v[44:47], v[92:95]
    v_perm_b32 v236, v197, v193, s57
    v_perm_b32 v237, v205, v201, s57
    v_perm_b32 v238, v213, v209, s57
    v_perm_b32 v239, v221, v217, s57
    v_mfma_f32_16x16x32_bf16 v[96:99], v[240:243], v[40:43], v[96:99]
    v_mfma_f32_16x16x32_bf16 v[100:103], v[240:243], v[44:47], v[100:103]
    v_perm_b32 v240, v198, v194, s56
    v_perm_b32 v241, v206, v202, s56
    v_perm_b32 v242, v214, v210, s56
    v_perm_b32 v243, v222, v218, s56
    v_mfma_f32_16x16x32_bf16 v[104:107], v[244:247], v[40:43], v[104:107]
    v_mfma_f32_16x16x32_bf16 v[108:111], v[244:247], v[44:47], v[108:111]
    v_perm_b32 v244, v198, v194, s57
    v_perm_b32 v245, v206, v202, s57
    v_perm_b32 v246, v214, v210, s57
    v_perm_b32 v247, v222, v218, s57
    v_mfma_f32_16x16x32_bf16 v[112:115], v[248:251], v[40:43], v[112:115]
    v_mfma_f32_16x16x32_bf16 v[116:119], v[248:251], v[44:47], v[116:119]
    v_perm_b32 v248, v199, v195, s56
    v_perm_b32 v249, v207, v203, s56
    v_perm_b32 v250, v215, v211, s56
    v_perm_b32 v251, v223, v219, s56
    v_mfma_f32_16x16x32_bf16 v[120:123], v[252:255], v[40:43], v[120:123]
    v_mfma_f32_16x16x32_bf16 v[124:127], v[252:255], v[44:47], v[124:127]
    v_add_u32 v15, s78, v5
    s_add_u32 s78, s78, 0x800
    s_and_b32 s78, s78, 0x7fff
    ds_read_b128 v[40:43], v15 offset:0
    ds_read_b128 v[44:47], v15 offset:1024
    v_perm_b32 v252, v199, v195, s57
    v_perm_b32 v253, v207, v203, s57
    v_perm_b32 v254, v215, v211, s57
    v_perm_b32 v255, v223, v219, s57
    s_waitcnt lgkmcnt(4)
    v_mfma_f32_16x16x32_bf16 v[64:67], v[224:227], v[32:35], v[64:67]
    s_waitcnt lgkmcnt(3)
    v_mfma_f32_16x16x32_bf16 v[68:71], v[224:227], v[36:39], v[68:71]
    v_perm_b32 v224, v132, v128, s56
    v_perm_b32 v225, v140, v136, s56
    v_perm_b32 v226, v148, v144, s56
    s_waitcnt lgkmcnt(2)
    v_perm_b32 v227, v156, v152, s56
    v_mfma_f32_16x16x32_bf16 v[72:75], v[228:231], v[32:35], v[72:75]
    v_mfma_f32_16x16x32_bf16 v[76:79], v[228:231], v[36:39], v[76:79]
    v_perm_b32 v228, v132, v128, s57
    v_perm_b32 v229, v140, v136, s57
    v_perm_b32 v230, v148, v144, s57
    v_perm_b32 v231, v156, v152, s57
    v_mfma_f32_16x16x32_bf16 v[80:83], v[232:235], v[32:35], v[80:83]
    v_mfma_f32_16x16x32_bf16 v[84:87], v[232:235], v[36:39], v[84:87]
    v_perm_b32 v232, v133, v129, s56
    v_perm_b32 v233, v141, v137, s56
    v_perm_b32 v234, v149, v145, s56
    v_perm_b32 v235, v157, v153, s56
    v_mfma_f32_16x16x32_bf16 v[88:91], v[236:239], v[32:35], v[88:91]
    v_mfma_f32_16x16x32_bf16 v[92:95], v[236:239], v[36:39], v[92:95]
    v_perm_b32 v236, v133, v129, s57
    v_perm_b32 v237, v141, v137, s57
    v_perm_b32 v238, v149, v145, s57
    v_perm_b32 v239, v157, v153, s57
    v_mfma_f32_16x16x32_bf16 v[96:99], v[240:243], v[32:35], v[96:99]
    v_mfma_f32_16x16x32_bf16 v[100:103], v[240:243], v[36:39], v[100:103]
    v_perm_b32 v240, v134, v130, s56
    v_perm_b32 v241, v142, v138, s56
    v_perm_b32 v242, v150, v146, s56
    v_perm_b32 v243, v158, v154, s56
    v_mfma_f32_16x16x32_bf16 v[104:107], v[244:247], v[32:35], v[104:107]
    v_mfma_f32_16x16x32_bf16 v[108:111], v[244:247], v[36:39], v[108:111]
    v_perm_b32 v244, v134, v130, s57
    v_perm_b32 v245, v142, v138, s57
    v_perm_b32 v246, v150, v146, s57
    v_perm_b32 v247, v158, v154, s57
    v_mfma_f32_16x16x32_bf16 v[112:115], v[248:251], v[32:35], v[112:115]
    v_mfma_f32_16x16x32_bf16 v[116:119], v[248:251], v[36:39], v[116:119]
    v_perm_b32 v248, v135, v131, s56
    v_perm_b32 v249, v143, v139, s56
    v_perm_b32 v250, v151, v147, s56
    v_perm_b32 v251, v159, v155, s56
    v_mfma_f32_16x16x32_bf16 v[120:123], v[252:255], v[32:35], v[120:123]
    v_mfma_f32_16x16x32_bf16 v[124:127], v[252:255], v[36:39], v[124:127]
    v_perm_b32 v252, v135, v131, s57
    v_perm_b32 v253, v143, v139, s57
    v_perm_b32 v254, v151, v147, s57
    v_perm_b32 v255, v159, v155, s57
    s_waitcnt lgkmcnt(1)
    v_mfma_f32_16x16x32_bf16 v[64:67], v[224:227], v[40:43], v[64:67]
    s_waitcnt lgkmcnt(0)
    v_mfma_f32_16x16x32_bf16 v[68:71], v[224:227], v[44:47], v[68:71]
    v_mfma_f32_16x16x32_bf16 v[72:75], v[228:231], v[40:43], v[72:75]
    v_mfma_f32_16x16x32_bf16 v[76:79], v[228:231], v[44:47], v[76:79]
    v_mfma_f32_16x16x32_bf16 v[80:83], v[232:235], v[40:43], v[80:83]
    v_mfma_f32_16x16x32_bf16 v[84:87], v[232:235], v[44:47], v[84:87]
    v_mfma_f32_16x16x32_bf16 v[88:91], v[236:239], v[40:43], v[88:91]
    v_mfma_f32_16x16x32_bf16 v[92:95], v[236:239], v[44:47], v[92:95]
    v_mfma_f32_16x16x32_bf16 v[96:99], v[240:243], v[40:43], v[96:99]
    v_mfma_f32_16x16x32_bf16 v[100:103], v[240:243], v[44:47], v[100:103]
    v_mfma_f32_16x16x32_bf16 v[104:107], v[244:247], v[40:43], v[104:107]
    v_mfma_f32_16x16x32_bf16 v[108:111], v[244:247], v[44:47], v[108:111]
    v_mfma_f32_16x16x32_bf16 v[112:115], v[248:251], v[40:43], v[112:115]
    v_mfma_f32_16x16x32_bf16 v[116:119], v[248:251], v[44:47], v[116:119]
    v_mfma_f32_16x16x32_bf16 v[120:123], v[252:255], v[40:43], v[120:123]
    v_mfma_f32_16x16x32_bf16 v[124:127], v[252:255], v[44:47], v[124:127]
    v_cvt_pk_bf16_f32 v128, v64, v72
    s_nop 1
    v_cvt_pk_bf16_f32 v129, v80, v88
    s_nop 2
    v_cvt_pk_bf16_f32 v130, v96, v104
    s_nop 2
    v_cvt_pk_bf16_f32 v131, v112, v120
    buffer_store_dwordx4 v[128:131], v13, s[52:55], s70 offen
    v_cvt_pk_bf16_f32 v132, v65, v73
    v_cvt_pk_bf16_f32 v133, v81, v89
    v_cvt_pk_bf16_f32 v134, v97, v105
    v_cvt_pk_bf16_f32 v135, v113, v121
    buffer_store_dwordx4 v[132:135], v13, s[52:55], s70 offen offset:1024
    v_cvt_pk_bf16_f32 v136, v66, v74
    v_cvt_pk_bf16_f32 v137, v82, v90
    v_cvt_pk_bf16_f32 v138, v98, v106
    v_cvt_pk_bf16_f32 v139, v114, v122
    buffer_store_dwordx4 v[136:139], v13, s[52:55], s70 offen offset:2048
    v_cvt_pk_bf16_f32 v140, v67, v75
    v_cvt_pk_bf16_f32 v141, v83, v91
    v_cvt_pk_bf16_f32 v142, v99, v107
    v_cvt_pk_bf16_f32 v143, v115, v123
    buffer_store_dwordx4 v[140:143], v13, s[52:55], s70 offen offset:3072
    v_cvt_pk_bf16_f32 v144, v68, v76
    v_cvt_pk_bf16_f32 v145, v84, v92
    v_cvt_pk_bf16_f32 v146, v100, v108
    v_cvt_pk_bf16_f32 v147, v116, v124
    buffer_store_dwordx4 v[144:147], v13, s[52:55], s71 offen
    v_cvt_pk_bf16_f32 v148, v69, v77
    v_cvt_pk_bf16_f32 v149, v85, v93
    v_cvt_pk_bf16_f32 v150, v101, v109
    v_cvt_pk_bf16_f32 v151, v117, v125
    buffer_store_dwordx4 v[148:151], v13, s[52:55], s71 offen offset:1024
    v_cvt_pk_bf16_f32 v152, v70, v78
    v_cvt_pk_bf16_f32 v153, v86, v94
    v_cvt_pk_bf16_f32 v154, v102, v110
    v_cvt_pk_bf16_f32 v155, v118, v126
    buffer_store_dwordx4 v[152:155], v13, s[52:55], s71 offen offset:2048
    v_cvt_pk_bf16_f32 v156, v71, v79
    v_cvt_pk_bf16_f32 v157, v87, v95
    v_cvt_pk_bf16_f32 v158, v103, v111
    v_cvt_pk_bf16_f32 v159, v119, v127
    buffer_store_dwordx4 v[156:159], v13, s[52:55], s71 offen offset:3072
    s_endpgm
L_kprod:
    v_and_b32 v3, 15, v1
    v_lshlrev_b32 v2, 10, v3
    v_lshrrev_b32 v3, 4, v1
    v_lshlrev_b32 v3, 4, v3
    v_add_u32 v2, v2, v3
    v_lshrrev_b32 v8, 4, v1
    v_and_b32 v9, 15, v1
    v_lshlrev_b32 v10, 8, v8
    v_add_u32 v11, 0, v8
    v_xor_b32 v11, v9, v11
    v_lshlrev_b32 v11, 4, v11
    v_add_u32 v4, v10, v11
    v_add_u32 v11, 4, v8
    v_xor_b32 v11, v9, v11
    v_lshlrev_b32 v11, 4, v11
    v_add_u32 v5, v10, v11
    v_add_u32 v11, 8, v8
    v_xor_b32 v11, v9, v11
    v_lshlrev_b32 v11, 4, v11
    v_add_u32 v6, v10, v11
    v_add_u32 v11, 12, v8
    v_xor_b32 v11, v9, v11
    v_lshlrev_b32 v11, 4, v11
    v_add_u32 v7, v10, v11
    s_lshl_b32 s76, s5, 15
    s_lshl_b32 s77, s2, 17
    s_add_u32 s78, s76, 0
    s_mov_b32 m0, 131072
    s_nop 0
    buffer_load_dwordx4 v2, s[32:35], s78 offen lds
    s_add_u32 s78, s76, 16384
    s_mov_b32 m0, 132096
    s_nop 0
    buffer_load_dwordx4 v2, s[32:35], s78 offen lds
    s_add_u32 s78, s76, 64
    s_mov_b32 m0, 133120
    s_nop 0
    buffer_load_dwordx4 v2, s[32:35], s78 offen lds
    s_add_u32 s78, s76, 16448
    s_mov_b32 m0, 134144
    s_nop 0
    buffer_load_dwordx4 v2, s[32:35], s78 offen lds
    s_add_u32 s78, s76, 128
    s_mov_b32 m0, 135168
    s_nop 0
    buffer_load_dwordx4 v2, s[32:35], s78 offen lds
    s_add_u32 s78, s76, 16512
    s_mov_b32 m0, 136192
    s_nop 0
    buffer_load_dwordx4 v2, s[32:35], s78 offen lds
    s_add_u32 s78, s76, 192
    s_mov_b32 m0, 137216
    s_nop 0
    buffer_load_dwordx4 v2, s[32:35], s78 offen lds
    s_add_u32 s78, s76, 16576
    s_mov_b32 m0, 138240
    s_nop 0
    buffer_load_dwordx4 v2, s[32:35], s78 offen lds
    s_add_u32 s78, s76, 256
    s_mov_b32 m0, 139264
    s_nop 0
    buffer_load_dwordx4 v2, s[32:35], s78 offen lds
    s_add_u32 s78, s76, 16640
    s_mov_b32 m0, 140288
    s_nop 0
    buffer_load_dwordx4 v2, s[32:35], s78 offen lds
    s_add_u32 s78, s76, 320
    s_mov_b32 m0, 141312
    s_nop 0
    buffer_load_dwordx4 v2, s[32:35], s78 offen lds
    s_add_u32 s78, s76, 16704
    s_mov_b32 m0, 142336
    s_nop 0
    buffer_load_dwordx4 v2, s[32:35], s78 offen lds
    s_add_u32 s78, s76, 384
    s_mov_b32 m0, 143360
    s_nop 0
    buffer_load_dwordx4 v2, s[32:35], s78 offen lds
    s_add_u32 s78, s76, 16768
    s_mov_b32 m0, 144384
    s_nop 0
    buffer_load_dwordx4 v2, s[32:35], s78 offen lds
    s_add_u32 s78, s76, 448
    s_mov_b32 m0, 145408
    s_nop 0
    buffer_load_dwordx4 v2, s[32:35], s78 offen lds
    s_add_u32 s78, s76, 16832
    s_mov_b32 m0, 146432
    s_nop 0
    buffer_load_dwordx4 v2, s[32:35], s78 offen lds
    v_lshlrev_b32 v12, 4, v1
    s_lshl_b32 s79, s5, 17
    s_lshl_b32 s78, s4, 10
    s_add_u32 s79, s79, s78
    s_add_u32 s78, s79, 0
    buffer_load_dwordx4 v[32:35], v12, s[44:47], s78 offen
    s_add_u32 s78, s79, 8192
    buffer_load_dwordx4 v[36:39], v12, s[44:47], s78 offen
    s_add_u32 s78, s79, 16384
    buffer_load_dwordx4 v[40:43], v12, s[44:47], s78 offen
    s_add_u32 s78, s79, 24576
    buffer_load_dwordx4 v[44:47], v12, s[44:47], s78 offen
    s_add_u32 s78, s79, 32768
    buffer_load_dwordx4 v[48:51], v12, s[44:47], s78 offen
    s_add_u32 s78, s79, 40960
    buffer_load_dwordx4 v[52:55], v12, s[44:47], s78 offen
    s_add_u32 s78, s79, 49152
    buffer_load_dwordx4 v[56:59], v12, s[44:47], s78 offen
    s_add_u32 s78, s79, 57344
    buffer_load_dwordx4 v[60:63], v12, s[44:47], s78 offen
    s_add_u32 s78, s77, 0
    s_mov_b32 m0, 0
    s_nop 0
    buffer_load_dwordx4 v4, s[36:39], s78 offen nt lds
    buffer_load_dwordx4 v5, s[36:39], s78 offen offset:1024 nt lds
    buffer_load_dwordx4 v6, s[36:39], s78 offen offset:2048 nt lds
    buffer_load_dwordx4 v7, s[36:39], s78 offen offset:3072 nt lds
    s_add_u32 s78, s77, 4096
    s_mov_b32 m0, 4096
    s_nop 0
    buffer_load_dwordx4 v4, s[36:39], s78 offen nt lds
    buffer_load_dwordx4 v5, s[36:39], s78 offen offset:1024 nt lds
    buffer_load_dwordx4 v6, s[36:39], s78 offen offset:2048 nt lds
    buffer_load_dwordx4 v7, s[36:39], s78 offen offset:3072 nt lds
    s_add_u32 s78, s77, 8192
    s_mov_b32 m0, 8192
    s_nop 0
    buffer_load_dwordx4 v4, s[36:39], s78 offen nt lds
    buffer_load_dwordx4 v5, s[36:39], s78 offen offset:1024 nt lds
    buffer_load_dwordx4 v6, s[36:39], s78 offen offset:2048 nt lds
    buffer_load_dwordx4 v7, s[36:39], s78 offen offset:3072 nt lds
    s_add_u32 s78, s77, 12288
    s_mov_b32 m0, 12288
    s_nop 0
    buffer_load_dwordx4 v4, s[36:39], s78 offen nt lds
    buffer_load_dwordx4 v5, s[36:39], s78 offen offset:1024 nt lds
    buffer_load_dwordx4 v6, s[36:39], s78 offen offset:2048 nt lds
    buffer_load_dwordx4 v7, s[36:39], s78 offen offset:3072 nt lds
    s_add_u32 s78, s77, 16384
    s_mov_b32 m0, 16384
    s_nop 0
    buffer_load_dwordx4 v4, s[36:39], s78 offen nt lds
    buffer_load_dwordx4 v5, s[36:39], s78 offen offset:1024 nt lds
    buffer_load_dwordx4 v6, s[36:39], s78 offen offset:2048 nt lds
    buffer_load_dwordx4 v7, s[36:39], s78 offen offset:3072 nt lds
    s_add_u32 s78, s77, 20480
    s_mov_b32 m0, 20480
    s_nop 0
    buffer_load_dwordx4 v4, s[36:39], s78 offen nt lds
    buffer_load_dwordx4 v5, s[36:39], s78 offen offset:1024 nt lds
    buffer_load_dwordx4 v6, s[36:39], s78 offen offset:2048 nt lds
    buffer_load_dwordx4 v7, s[36:39], s78 offen offset:3072 nt lds
    s_add_u32 s78, s77, 24576
    s_mov_b32 m0, 24576
    s_nop 0
    buffer_load_dwordx4 v4, s[36:39], s78 offen nt lds
    buffer_load_dwordx4 v5, s[36:39], s78 offen offset:1024 nt lds
    buffer_load_dwordx4 v6, s[36:39], s78 offen offset:2048 nt lds
    buffer_load_dwordx4 v7, s[36:39], s78 offen offset:3072 nt lds
    s_add_u32 s78, s77, 28672
    s_mov_b32 m0, 28672
    s_nop 0
    buffer_load_dwordx4 v4, s[36:39], s78 offen nt lds
    buffer_load_dwordx4 v5, s[36:39], s78 offen offset:1024 nt lds
    buffer_load_dwordx4 v6, s[36:39], s78 offen offset:2048 nt lds
    buffer_load_dwordx4 v7, s[36:39], s78 offen offset:3072 nt lds
    s_waitcnt vmcnt(32)
    s_barrier
    s_add_u32 s78, s77, 32768
    s_mov_b32 m0, 32768
    s_nop 0
    buffer_load_dwordx4 v4, s[36:39], s78 offen nt lds
    buffer_load_dwordx4 v5, s[36:39], s78 offen offset:1024 nt lds
    buffer_load_dwordx4 v6, s[36:39], s78 offen offset:2048 nt lds
    buffer_load_dwordx4 v7, s[36:39], s78 offen offset:3072 nt lds
    s_add_u32 s78, s77, 36864
    s_mov_b32 m0, 36864
    s_nop 0
    buffer_load_dwordx4 v4, s[36:39], s78 offen nt lds
    buffer_load_dwordx4 v5, s[36:39], s78 offen offset:1024 nt lds
    buffer_load_dwordx4 v6, s[36:39], s78 offen offset:2048 nt lds
    buffer_load_dwordx4 v7, s[36:39], s78 offen offset:3072 nt lds
    s_add_u32 s78, s77, 40960
    s_mov_b32 m0, 40960
    s_nop 0
    buffer_load_dwordx4 v4, s[36:39], s78 offen nt lds
    buffer_load_dwordx4 v5, s[36:39], s78 offen offset:1024 nt lds
    buffer_load_dwordx4 v6, s[36:39], s78 offen offset:2048 nt lds
    buffer_load_dwordx4 v7, s[36:39], s78 offen offset:3072 nt lds
    s_add_u32 s78, s77, 45056
    s_mov_b32 m0, 45056
    s_nop 0
    buffer_load_dwordx4 v4, s[36:39], s78 offen nt lds
    buffer_load_dwordx4 v5, s[36:39], s78 offen offset:1024 nt lds
    buffer_load_dwordx4 v6, s[36:39], s78 offen offset:2048 nt lds
    buffer_load_dwordx4 v7, s[36:39], s78 offen offset:3072 nt lds
    s_add_u32 s78, s77, 49152
    s_mov_b32 m0, 49152
    s_nop 0
    buffer_load_dwordx4 v4, s[36:39], s78 offen nt lds
    buffer_load_dwordx4 v5, s[36:39], s78 offen offset:1024 nt lds
    buffer_load_dwordx4 v6, s[36:39], s78 offen offset:2048 nt lds
    buffer_load_dwordx4 v7, s[36:39], s78 offen offset:3072 nt lds
    s_add_u32 s78, s77, 53248
    s_mov_b32 m0, 53248
    s_nop 0
    buffer_load_dwordx4 v4, s[36:39], s78 offen nt lds
    buffer_load_dwordx4 v5, s[36:39], s78 offen offset:1024 nt lds
    buffer_load_dwordx4 v6, s[36:39], s78 offen offset:2048 nt lds
    buffer_load_dwordx4 v7, s[36:39], s78 offen offset:3072 nt lds
    s_add_u32 s78, s77, 57344
    s_mov_b32 m0, 57344
    s_nop 0
    buffer_load_dwordx4 v4, s[36:39], s78 offen nt lds
    buffer_load_dwordx4 v5, s[36:39], s78 offen offset:1024 nt lds
    buffer_load_dwordx4 v6, s[36:39], s78 offen offset:2048 nt lds
    buffer_load_dwordx4 v7, s[36:39], s78 offen offset:3072 nt lds
    s_add_u32 s78, s77, 61440
    s_mov_b32 m0, 61440
    s_nop 0
    buffer_load_dwordx4 v4, s[36:39], s78 offen nt lds
    buffer_load_dwordx4 v5, s[36:39], s78 offen offset:1024 nt lds
    buffer_load_dwordx4 v6, s[36:39], s78 offen offset:2048 nt lds
    s_waitcnt vmcnt(62)
    buffer_load_dwordx4 v7, s[36:39], s78 offen offset:3072 nt lds
    s_waitcnt vmcnt(32)
    s_barrier
    s_add_u32 s78, s77, 65536
    s_mov_b32 m0, 131072
    s_nop 0
    buffer_load_dwordx4 v4, s[36:39], s78 offen nt lds
    buffer_load_dwordx4 v5, s[36:39], s78 offen offset:1024 nt lds
    buffer_load_dwordx4 v6, s[36:39], s78 offen offset:2048 nt lds
    buffer_load_dwordx4 v7, s[36:39], s78 offen offset:3072 nt lds
    s_add_u32 s78, s77, 69632
    s_mov_b32 m0, 135168
    s_nop 0
    buffer_load_dwordx4 v4, s[36:39], s78 offen nt lds
    buffer_load_dwordx4 v5, s[36:39], s78 offen offset:1024 nt lds
    buffer_load_dwordx4 v6, s[36:39], s78 offen offset:2048 nt lds
    buffer_load_dwordx4 v7, s[36:39], s78 offen offset:3072 nt lds
    s_add_u32 s78, s77, 73728
    s_mov_b32 m0, 139264
    s_nop 0
    buffer_load_dwordx4 v4, s[36:39], s78 offen nt lds
    buffer_load_dwordx4 v5, s[36:39], s78 offen offset:1024 nt lds
    buffer_load_dwordx4 v6, s[36:39], s78 offen offset:2048 nt lds
    buffer_load_dwordx4 v7, s[36:39], s78 offen offset:3072 nt lds
    s_add_u32 s78, s77, 77824
    s_mov_b32 m0, 143360
    s_nop 0
    buffer_load_dwordx4 v4, s[36:39], s78 offen nt lds
    buffer_load_dwordx4 v5, s[36:39], s78 offen offset:1024 nt lds
    buffer_load_dwordx4 v6, s[36:39], s78 offen offset:2048 nt lds
    buffer_load_dwordx4 v7, s[36:39], s78 offen offset:3072 nt lds
    s_barrier
    s_add_u32 s78, s77, 81920
    s_mov_b32 m0, 0
    s_nop 0
    buffer_load_dwordx4 v4, s[36:39], s78 offen nt lds
    buffer_load_dwordx4 v5, s[36:39], s78 offen offset:1024 nt lds
    buffer_load_dwordx4 v6, s[36:39], s78 offen offset:2048 nt lds
    buffer_load_dwordx4 v7, s[36:39], s78 offen offset:3072 nt lds
    s_add_u32 s78, s77, 86016
    s_mov_b32 m0, 4096
    s_nop 0
    buffer_load_dwordx4 v4, s[36:39], s78 offen nt lds
    buffer_load_dwordx4 v5, s[36:39], s78 offen offset:1024 nt lds
    buffer_load_dwordx4 v6, s[36:39], s78 offen offset:2048 nt lds
    buffer_load_dwordx4 v7, s[36:39], s78 offen offset:3072 nt lds
    s_add_u32 s78, s77, 90112
    s_mov_b32 m0, 8192
    s_nop 0
    buffer_load_dwordx4 v4, s[36:39], s78 offen nt lds
    buffer_load_dwordx4 v5, s[36:39], s78 offen offset:1024 nt lds
    buffer_load_dwordx4 v6, s[36:39], s78 offen offset:2048 nt lds
    buffer_load_dwordx4 v7, s[36:39], s78 offen offset:3072 nt lds
    s_add_u32 s78, s77, 94208
    s_mov_b32 m0, 12288
    s_nop 0
    buffer_load_dwordx4 v4, s[36:39], s78 offen nt lds
    buffer_load_dwordx4 v5, s[36:39], s78 offen offset:1024 nt lds
    buffer_load_dwordx4 v6, s[36:39], s78 offen offset:2048 nt lds
    s_waitcnt vmcnt(62)
    buffer_load_dwordx4 v7, s[36:39], s78 offen offset:3072 nt lds
    s_waitcnt vmcnt(48)
    s_barrier
    s_add_u32 s78, s77, 98304
    s_mov_b32 m0, 16384
    s_nop 0
    buffer_load_dwordx4 v4, s[36:39], s78 offen nt lds
    buffer_load_dwordx4 v5, s[36:39], s78 offen offset:1024 nt lds
    buffer_load_dwordx4 v6, s[36:39], s78 offen offset:2048 nt lds
    buffer_load_dwordx4 v7, s[36:39], s78 offen offset:3072 nt lds
    s_add_u32 s78, s77, 102400
    s_mov_b32 m0, 20480
    s_nop 0
    buffer_load_dwordx4 v4, s[36:39], s78 offen nt lds
    buffer_load_dwordx4 v5, s[36:39], s78 offen offset:1024 nt lds
    buffer_load_dwordx4 v6, s[36:39], s78 offen offset:2048 nt lds
    buffer_load_dwordx4 v7, s[36:39], s78 offen offset:3072 nt lds
    s_add_u32 s78, s77, 106496
    s_mov_b32 m0, 24576
    s_nop 0
    buffer_load_dwordx4 v4, s[36:39], s78 offen nt lds
    buffer_load_dwordx4 v5, s[36:39], s78 offen offset:1024 nt lds
    buffer_load_dwordx4 v6, s[36:39], s78 offen offset:2048 nt lds
    buffer_load_dwordx4 v7, s[36:39], s78 offen offset:3072 nt lds
    s_add_u32 s78, s77, 110592
    s_mov_b32 m0, 28672
    s_nop 0
    buffer_load_dwordx4 v4, s[36:39], s78 offen nt lds
    buffer_load_dwordx4 v5, s[36:39], s78 offen offset:1024 nt lds
    buffer_load_dwordx4 v6, s[36:39], s78 offen offset:2048 nt lds
    s_waitcnt vmcnt(62)
    buffer_load_dwordx4 v7, s[36:39], s78 offen offset:3072 nt lds
    s_waitcnt vmcnt(48)
    s_barrier
    s_add_u32 s78, s77, 114688
    s_mov_b32 m0, 32768
    s_nop 0
    buffer_load_dwordx4 v4, s[36:39], s78 offen nt lds
    buffer_load_dwordx4 v5, s[36:39], s78 offen offset:1024 nt lds
    buffer_load_dwordx4 v6, s[36:39], s78 offen offset:2048 nt lds
    buffer_load_dwordx4 v7, s[36:39], s78 offen offset:3072 nt lds
    s_add_u32 s78, s77, 118784
    s_mov_b32 m0, 36864
    s_nop 0
    buffer_load_dwordx4 v4, s[36:39], s78 offen nt lds
    buffer_load_dwordx4 v5, s[36:39], s78 offen offset:1024 nt lds
    buffer_load_dwordx4 v6, s[36:39], s78 offen offset:2048 nt lds
    buffer_load_dwordx4 v7, s[36:39], s78 offen offset:3072 nt lds
    s_add_u32 s78, s77, 122880
    s_mov_b32 m0, 40960
    s_nop 0
    buffer_load_dwordx4 v4, s[36:39], s78 offen nt lds
    buffer_load_dwordx4 v5, s[36:39], s78 offen offset:1024 nt lds
    buffer_load_dwordx4 v6, s[36:39], s78 offen offset:2048 nt lds
    buffer_load_dwordx4 v7, s[36:39], s78 offen offset:3072 nt lds
    s_add_u32 s78, s77, 126976
    s_mov_b32 m0, 45056
    s_nop 0
    buffer_load_dwordx4 v4, s[36:39], s78 offen nt lds
    buffer_load_dwordx4 v5, s[36:39], s78 offen offset:1024 nt lds
    buffer_load_dwordx4 v6, s[36:39], s78 offen offset:2048 nt lds
    s_waitcnt vmcnt(62)
    buffer_load_dwordx4 v7, s[36:39], s78 offen offset:3072 nt lds
    s_waitcnt vmcnt(48)
    s_barrier
    v_lshrrev_b32 v16, 5, v1
    v_lshlrev_b32 v13, 14, v16
    v_lshrrev_b32 v16, 4, v1
    v_and_b32 v16, 1, v16
    v_lshlrev_b32 v16, 12, v16
    v_add_u32 v13, v13, v16
    v_and_b32 v16, 15, v1
    v_lshlrev_b32 v16, 4, v16
    v_add_u32 v13, v13, v16
    v_add_u32 v14, 0x2000, v13
    s_lshr_b32 s72, s5, 1
    s_lshl_b32 s79, s4, 19
    s_lshl_b32 s78, s5, 14
    s_add_u32 s79, s79, s78
    s_add_u32 s78, s79, 0
    buffer_load_dwordx4 v[160:163], v12, s[48:51], s78 offen
    s_add_u32 s78, s79, 1024
    buffer_load_dwordx4 v[164:167], v12, s[48:51], s78 offen
    s_add_u32 s78, s79, 2048
    buffer_load_dwordx4 v[168:171], v12, s[48:51], s78 offen
    s_add_u32 s78, s79, 3072
    buffer_load_dwordx4 v[172:175], v12, s[48:51], s78 offen
    s_add_u32 s78, s79, 4096
    buffer_load_dwordx4 v[176:179], v12, s[48:51], s78 offen
    s_add_u32 s78, s79, 5120
    buffer_load_dwordx4 v[180:183], v12, s[48:51], s78 offen
    s_add_u32 s78, s79, 6144
    buffer_load_dwordx4 v[184:187], v12, s[48:51], s78 offen
    s_add_u32 s78, s79, 7168
    buffer_load_dwordx4 v[188:191], v12, s[48:51], s78 offen
    s_add_u32 s78, s79, 8192
    buffer_load_dwordx4 v[192:195], v12, s[48:51], s78 offen
    s_add_u32 s78, s79, 9216
    buffer_load_dwordx4 v[196:199], v12, s[48:51], s78 offen
    s_add_u32 s78, s79, 10240
    buffer_load_dwordx4 v[200:203], v12, s[48:51], s78 offen
    s_add_u32 s78, s79, 11264
    buffer_load_dwordx4 v[204:207], v12, s[48:51], s78 offen
    s_add_u32 s78, s79, 12288
    buffer_load_dwordx4 v[208:211], v12, s[48:51], s78 offen
    s_add_u32 s78, s79, 13312
    buffer_load_dwordx4 v[212:215], v12, s[48:51], s78 offen
    s_add_u32 s78, s79, 14336
    buffer_load_dwordx4 v[216:219], v12, s[48:51], s78 offen
    s_add_u32 s78, s79, 15360
    s_waitcnt vmcnt(62)
    buffer_load_dwordx4 v[220:223], v12, s[48:51], s78 offen
    s_add_u32 s73, s72, 13
    s_and_b32 s73, s73, 15
    s_lshl_b32 s73, s73, 15
    s_lshl_b32 s74, s4, 19
    s_or_b32 s73, s73, s74
    s_add_u32 s74, s73, 0
    s_mov_b32 m0, 49152
    s_waitcnt vmcnt(62)
    buffer_load_dwordx4 v13, s[48:51], s74 offen lds
    s_waitcnt vmcnt(62)
    buffer_load_dwordx4 v13, s[48:51], s74 offen offset:1024 lds
    s_waitcnt vmcnt(62)
    buffer_load_dwordx4 v13, s[48:51], s74 offen offset:2048 lds
    s_waitcnt vmcnt(62)
    buffer_load_dwordx4 v13, s[48:51], s74 offen offset:3072 lds
    s_mov_b32 m0, 53248
    s_waitcnt vmcnt(62)
    buffer_load_dwordx4 v14, s[48:51], s74 offen lds
    s_waitcnt vmcnt(62)
    buffer_load_dwordx4 v14, s[48:51], s74 offen offset:1024 lds
    s_waitcnt vmcnt(62)
    buffer_load_dwordx4 v14, s[48:51], s74 offen offset:2048 lds
    s_waitcnt vmcnt(62)
    buffer_load_dwordx4 v14, s[48:51], s74 offen offset:3072 lds
    s_add_u32 s74, s73, 256
    s_mov_b32 m0, 57344
    s_waitcnt vmcnt(62)
    buffer_load_dwordx4 v13, s[48:51], s74 offen lds
    s_waitcnt vmcnt(62)
    buffer_load_dwordx4 v13, s[48:51], s74 offen offset:1024 lds
    s_waitcnt vmcnt(62)
    buffer_load_dwordx4 v13, s[48:51], s74 offen offset:2048 lds
    s_waitcnt vmcnt(62)
    buffer_load_dwordx4 v13, s[48:51], s74 offen offset:3072 lds
    s_mov_b32 m0, 61440
    s_waitcnt vmcnt(62)
    buffer_load_dwordx4 v14, s[48:51], s74 offen lds
    s_waitcnt vmcnt(62)
    buffer_load_dwordx4 v14, s[48:51], s74 offen offset:1024 lds
    s_waitcnt vmcnt(62)
    buffer_load_dwordx4 v14, s[48:51], s74 offen offset:2048 lds
    s_waitcnt vmcnt(62)
    buffer_load_dwordx4 v14, s[48:51], s74 offen offset:3072 lds
    s_barrier
    s_add_u32 s73, s72, 13
    s_and_b32 s73, s73, 15
    s_lshl_b32 s73, s73, 15
    s_lshl_b32 s74, s4, 19
    s_or_b32 s73, s73, s74
    s_add_u32 s74, s73, 512
    s_mov_b32 m0, 131072
    s_waitcnt vmcnt(62)
    buffer_load_dwordx4 v13, s[48:51], s74 offen lds
    s_waitcnt vmcnt(62)
    buffer_load_dwordx4 v13, s[48:51], s74 offen offset:1024 lds
    s_waitcnt vmcnt(62)
    buffer_load_dwordx4 v13, s[48:51], s74 offen offset:2048 lds
    s_waitcnt vmcnt(62)
    buffer_load_dwordx4 v13, s[48:51], s74 offen offset:3072 lds
    s_mov_b32 m0, 135168
    s_waitcnt vmcnt(62)
    buffer_load_dwordx4 v14, s[48:51], s74 offen lds
    s_waitcnt vmcnt(62)
    buffer_load_dwordx4 v14, s[48:51], s74 offen offset:1024 lds
    s_waitcnt vmcnt(62)
    buffer_load_dwordx4 v14, s[48:51], s74 offen offset:2048 lds
    s_waitcnt vmcnt(62)
    buffer_load_dwordx4 v14, s[48:51], s74 offen offset:3072 lds
    s_add_u32 s74, s73, 768
    s_mov_b32 m0, 139264
    s_waitcnt vmcnt(62)
    buffer_load_dwordx4 v13, s[48:51], s74 offen lds
    s_waitcnt vmcnt(62)
    buffer_load_dwordx4 v13, s[48:51], s74 offen offset:1024 lds
    s_waitcnt vmcnt(62)
    buffer_load_dwordx4 v13, s[48:51], s74 offen offset:2048 lds
    s_waitcnt vmcnt(62)
    buffer_load_dwordx4 v13, s[48:51], s74 offen offset:3072 lds
    s_mov_b32 m0, 143360
    s_waitcnt vmcnt(62)
    buffer_load_dwordx4 v14, s[48:51], s74 offen lds
    s_waitcnt vmcnt(62)
    buffer_load_dwordx4 v14, s[48:51], s74 offen offset:1024 lds
    s_waitcnt vmcnt(62)
    buffer_load_dwordx4 v14, s[48:51], s74 offen offset:2048 lds
    s_waitcnt vmcnt(62)
    buffer_load_dwordx4 v14, s[48:51], s74 offen offset:3072 lds
    s_barrier
    s_add_u32 s73, s72, 14
    s_and_b32 s73, s73, 15
    s_lshl_b32 s73, s73, 15
    s_lshl_b32 s74, s4, 19
    s_or_b32 s73, s73, s74
    s_add_u32 s74, s73, 0
    s_mov_b32 m0, 0
    s_waitcnt vmcnt(62)
    buffer_load_dwordx4 v13, s[48:51], s74 offen lds
    s_waitcnt vmcnt(62)
    buffer_load_dwordx4 v13, s[48:51], s74 offen offset:1024 lds
    s_waitcnt vmcnt(62)
    buffer_load_dwordx4 v13, s[48:51], s74 offen offset:2048 lds
    s_waitcnt vmcnt(62)
    buffer_load_dwordx4 v13, s[48:51], s74 offen offset:3072 lds
    s_mov_b32 m0, 4096
    s_waitcnt vmcnt(62)
    buffer_load_dwordx4 v14, s[48:51], s74 offen lds
    s_waitcnt vmcnt(62)
    buffer_load_dwordx4 v14, s[48:51], s74 offen offset:1024 lds
    s_waitcnt vmcnt(62)
    buffer_load_dwordx4 v14, s[48:51], s74 offen offset:2048 lds
    s_waitcnt vmcnt(62)
    buffer_load_dwordx4 v14, s[48:51], s74 offen offset:3072 lds
    s_add_u32 s74, s73, 256
    s_mov_b32 m0, 8192
    s_waitcnt vmcnt(62)
    buffer_load_dwordx4 v13, s[48:51], s74 offen lds
    s_waitcnt vmcnt(62)
    buffer_load_dwordx4 v13, s[48:51], s74 offen offset:1024 lds
    s_waitcnt vmcnt(62)
    buffer_load_dwordx4 v13, s[48:51], s74 offen offset:2048 lds
    s_waitcnt vmcnt(62)
    buffer_load_dwordx4 v13, s[48:51], s74 offen offset:3072 lds
    s_mov_b32 m0, 12288
    s_waitcnt vmcnt(62)
    buffer_load_dwordx4 v14, s[48:51], s74 offen lds
    s_waitcnt vmcnt(62)
    buffer_load_dwordx4 v14, s[48:51], s74 offen offset:1024 lds
    s_waitcnt vmcnt(62)
    buffer_load_dwordx4 v14, s[48:51], s74 offen offset:2048 lds
    s_waitcnt vmcnt(62)
    buffer_load_dwordx4 v14, s[48:51], s74 offen offset:3072 lds
    s_barrier
    s_barrier
    s_barrier
    s_waitcnt vmcnt(0)
    s_barrier
    s_endpgm
L_vprod:
    v_and_b32 v3, 15, v1
    v_lshlrev_b32 v2, 10, v3
    v_lshrrev_b32 v3, 4, v1
    v_lshlrev_b32 v3, 4, v3
    v_add_u32 v2, v2, v3
    v_lshrrev_b32 v8, 4, v1
    v_and_b32 v9, 15, v1
    v_lshlrev_b32 v10, 8, v8
    v_lshlrev_b32 v11, 2, v8
    v_or_b32 v11, 0, v11
    v_xor_b32 v11, v9, v11
    v_lshlrev_b32 v11, 4, v11
    v_add_u32 v4, v10, v11
    v_lshlrev_b32 v11, 2, v8
    v_or_b32 v11, 1, v11
    v_xor_b32 v11, v9, v11
    v_lshlrev_b32 v11, 4, v11
    v_add_u32 v5, v10, v11
    v_lshlrev_b32 v11, 2, v8
    v_or_b32 v11, 2, v11
    v_xor_b32 v11, v9, v11
    v_lshlrev_b32 v11, 4, v11
    v_add_u32 v6, v10, v11
    v_lshlrev_b32 v11, 2, v8
    v_or_b32 v11, 3, v11
    v_xor_b32 v11, v9, v11
    v_lshlrev_b32 v11, 4, v11
    v_add_u32 v7, v10, v11
    s_lshl_b32 s76, s5, 15
    s_lshl_b32 s77, s2, 17
    s_add_u32 s78, s76, 512
    s_mov_b32 m0, 147456
    s_nop 0
    buffer_load_dwordx4 v2, s[32:35], s78 offen lds
    s_add_u32 s78, s76, 16896
    s_mov_b32 m0, 148480
    s_nop 0
    buffer_load_dwordx4 v2, s[32:35], s78 offen lds
    s_add_u32 s78, s76, 576
    s_mov_b32 m0, 149504
    s_nop 0
    buffer_load_dwordx4 v2, s[32:35], s78 offen lds
    s_add_u32 s78, s76, 16960
    s_mov_b32 m0, 150528
    s_nop 0
    buffer_load_dwordx4 v2, s[32:35], s78 offen lds
    s_add_u32 s78, s76, 640
    s_mov_b32 m0, 151552
    s_nop 0
    buffer_load_dwordx4 v2, s[32:35], s78 offen lds
    s_add_u32 s78, s76, 17024
    s_mov_b32 m0, 152576
    s_nop 0
    buffer_load_dwordx4 v2, s[32:35], s78 offen lds
    s_add_u32 s78, s76, 704
    s_mov_b32 m0, 153600
    s_nop 0
    buffer_load_dwordx4 v2, s[32:35], s78 offen lds
    s_add_u32 s78, s76, 17088
    s_mov_b32 m0, 154624
    s_nop 0
    buffer_load_dwordx4 v2, s[32:35], s78 offen lds
    s_add_u32 s78, s76, 768
    s_mov_b32 m0, 155648
    s_nop 0
    buffer_load_dwordx4 v2, s[32:35], s78 offen lds
    s_add_u32 s78, s76, 17152
    s_mov_b32 m0, 156672
    s_nop 0
    buffer_load_dwordx4 v2, s[32:35], s78 offen lds
    s_add_u32 s78, s76, 832
    s_mov_b32 m0, 157696
    s_nop 0
    buffer_load_dwordx4 v2, s[32:35], s78 offen lds
    s_add_u32 s78, s76, 17216
    s_mov_b32 m0, 158720
    s_nop 0
    buffer_load_dwordx4 v2, s[32:35], s78 offen lds
    s_add_u32 s78, s76, 896
    s_mov_b32 m0, 159744
    s_nop 0
    buffer_load_dwordx4 v2, s[32:35], s78 offen lds
    s_add_u32 s78, s76, 17280
    s_mov_b32 m0, 160768
    s_nop 0
    buffer_load_dwordx4 v2, s[32:35], s78 offen lds
    s_add_u32 s78, s76, 960
    s_mov_b32 m0, 161792
    s_nop 0
    buffer_load_dwordx4 v2, s[32:35], s78 offen lds
    s_add_u32 s78, s76, 17344
    s_mov_b32 m0, 162816
    s_nop 0
    buffer_load_dwordx4 v2, s[32:35], s78 offen lds
    v_lshlrev_b32 v12, 4, v1
    s_lshl_b32 s79, s5, 17
    s_lshl_b32 s78, s4, 10
    s_add_u32 s79, s79, s78
    s_add_u32 s78, s79, 65536
    buffer_load_dwordx4 v[32:35], v12, s[44:47], s78 offen
    s_add_u32 s78, s79, 73728
    buffer_load_dwordx4 v[36:39], v12, s[44:47], s78 offen
    s_add_u32 s78, s79, 81920
    buffer_load_dwordx4 v[40:43], v12, s[44:47], s78 offen
    s_add_u32 s78, s79, 90112
    buffer_load_dwordx4 v[44:47], v12, s[44:47], s78 offen
    s_add_u32 s78, s79, 98304
    buffer_load_dwordx4 v[48:51], v12, s[44:47], s78 offen
    s_add_u32 s78, s79, 106496
    buffer_load_dwordx4 v[52:55], v12, s[44:47], s78 offen
    s_add_u32 s78, s79, 114688
    buffer_load_dwordx4 v[56:59], v12, s[44:47], s78 offen
    s_add_u32 s78, s79, 122880
    buffer_load_dwordx4 v[60:63], v12, s[44:47], s78 offen
    s_add_u32 s78, s77, 0
    s_mov_b32 m0, 65536
    s_nop 0
    buffer_load_dwordx4 v4, s[40:43], s78 offen nt lds
    buffer_load_dwordx4 v5, s[40:43], s78 offen offset:1024 nt lds
    buffer_load_dwordx4 v6, s[40:43], s78 offen offset:2048 nt lds
    buffer_load_dwordx4 v7, s[40:43], s78 offen offset:3072 nt lds
    s_add_u32 s78, s77, 4096
    s_mov_b32 m0, 69632
    s_nop 0
    buffer_load_dwordx4 v4, s[40:43], s78 offen nt lds
    buffer_load_dwordx4 v5, s[40:43], s78 offen offset:1024 nt lds
    buffer_load_dwordx4 v6, s[40:43], s78 offen offset:2048 nt lds
    buffer_load_dwordx4 v7, s[40:43], s78 offen offset:3072 nt lds
    s_add_u32 s78, s77, 8192
    s_mov_b32 m0, 73728
    s_nop 0
    buffer_load_dwordx4 v4, s[40:43], s78 offen nt lds
    buffer_load_dwordx4 v5, s[40:43], s78 offen offset:1024 nt lds
    buffer_load_dwordx4 v6, s[40:43], s78 offen offset:2048 nt lds
    buffer_load_dwordx4 v7, s[40:43], s78 offen offset:3072 nt lds
    s_add_u32 s78, s77, 12288
    s_mov_b32 m0, 77824
    s_nop 0
    buffer_load_dwordx4 v4, s[40:43], s78 offen nt lds
    buffer_load_dwordx4 v5, s[40:43], s78 offen offset:1024 nt lds
    buffer_load_dwordx4 v6, s[40:43], s78 offen offset:2048 nt lds
    buffer_load_dwordx4 v7, s[40:43], s78 offen offset:3072 nt lds
    s_add_u32 s78, s77, 16384
    s_mov_b32 m0, 81920
    s_nop 0
    buffer_load_dwordx4 v4, s[40:43], s78 offen nt lds
    buffer_load_dwordx4 v5, s[40:43], s78 offen offset:1024 nt lds
    buffer_load_dwordx4 v6, s[40:43], s78 offen offset:2048 nt lds
    buffer_load_dwordx4 v7, s[40:43], s78 offen offset:3072 nt lds
    s_add_u32 s78, s77, 20480
    s_mov_b32 m0, 86016
    s_nop 0
    buffer_load_dwordx4 v4, s[40:43], s78 offen nt lds
    buffer_load_dwordx4 v5, s[40:43], s78 offen offset:1024 nt lds
    buffer_load_dwordx4 v6, s[40:43], s78 offen offset:2048 nt lds
    buffer_load_dwordx4 v7, s[40:43], s78 offen offset:3072 nt lds
    s_add_u32 s78, s77, 24576
    s_mov_b32 m0, 90112
    s_nop 0
    buffer_load_dwordx4 v4, s[40:43], s78 offen nt lds
    buffer_load_dwordx4 v5, s[40:43], s78 offen offset:1024 nt lds
    buffer_load_dwordx4 v6, s[40:43], s78 offen offset:2048 nt lds
    buffer_load_dwordx4 v7, s[40:43], s78 offen offset:3072 nt lds
    s_add_u32 s78, s77, 28672
    s_mov_b32 m0, 94208
    s_nop 0
    buffer_load_dwordx4 v4, s[40:43], s78 offen nt lds
    buffer_load_dwordx4 v5, s[40:43], s78 offen offset:1024 nt lds
    buffer_load_dwordx4 v6, s[40:43], s78 offen offset:2048 nt lds
    buffer_load_dwordx4 v7, s[40:43], s78 offen offset:3072 nt lds
    s_waitcnt vmcnt(32)
    s_barrier
    s_add_u32 s78, s77, 32768
    s_mov_b32 m0, 98304
    s_nop 0
    buffer_load_dwordx4 v4, s[40:43], s78 offen nt lds
    buffer_load_dwordx4 v5, s[40:43], s78 offen offset:1024 nt lds
    buffer_load_dwordx4 v6, s[40:43], s78 offen offset:2048 nt lds
    buffer_load_dwordx4 v7, s[40:43], s78 offen offset:3072 nt lds
    s_add_u32 s78, s77, 36864
    s_mov_b32 m0, 102400
    s_nop 0
    buffer_load_dwordx4 v4, s[40:43], s78 offen nt lds
    buffer_load_dwordx4 v5, s[40:43], s78 offen offset:1024 nt lds
    buffer_load_dwordx4 v6, s[40:43], s78 offen offset:2048 nt lds
    buffer_load_dwordx4 v7, s[40:43], s78 offen offset:3072 nt lds
    s_add_u32 s78, s77, 40960
    s_mov_b32 m0, 106496
    s_nop 0
    buffer_load_dwordx4 v4, s[40:43], s78 offen nt lds
    buffer_load_dwordx4 v5, s[40:43], s78 offen offset:1024 nt lds
    buffer_load_dwordx4 v6, s[40:43], s78 offen offset:2048 nt lds
    buffer_load_dwordx4 v7, s[40:43], s78 offen offset:3072 nt lds
    s_add_u32 s78, s77, 45056
    s_mov_b32 m0, 110592
    s_nop 0
    buffer_load_dwordx4 v4, s[40:43], s78 offen nt lds
    buffer_load_dwordx4 v5, s[40:43], s78 offen offset:1024 nt lds
    buffer_load_dwordx4 v6, s[40:43], s78 offen offset:2048 nt lds
    buffer_load_dwordx4 v7, s[40:43], s78 offen offset:3072 nt lds
    s_add_u32 s78, s77, 49152
    s_mov_b32 m0, 114688
    s_nop 0
    buffer_load_dwordx4 v4, s[40:43], s78 offen nt lds
    buffer_load_dwordx4 v5, s[40:43], s78 offen offset:1024 nt lds
    buffer_load_dwordx4 v6, s[40:43], s78 offen offset:2048 nt lds
    buffer_load_dwordx4 v7, s[40:43], s78 offen offset:3072 nt lds
    s_add_u32 s78, s77, 53248
    s_mov_b32 m0, 118784
    s_nop 0
    buffer_load_dwordx4 v4, s[40:43], s78 offen nt lds
    buffer_load_dwordx4 v5, s[40:43], s78 offen offset:1024 nt lds
    buffer_load_dwordx4 v6, s[40:43], s78 offen offset:2048 nt lds
    buffer_load_dwordx4 v7, s[40:43], s78 offen offset:3072 nt lds
    s_add_u32 s78, s77, 57344
    s_mov_b32 m0, 122880
    s_nop 0
    buffer_load_dwordx4 v4, s[40:43], s78 offen nt lds
    buffer_load_dwordx4 v5, s[40:43], s78 offen offset:1024 nt lds
    buffer_load_dwordx4 v6, s[40:43], s78 offen offset:2048 nt lds
    buffer_load_dwordx4 v7, s[40:43], s78 offen offset:3072 nt lds
    s_add_u32 s78, s77, 61440
    s_mov_b32 m0, 126976
    s_nop 0
    buffer_load_dwordx4 v4, s[40:43], s78 offen nt lds
    buffer_load_dwordx4 v5, s[40:43], s78 offen offset:1024 nt lds
    buffer_load_dwordx4 v6, s[40:43], s78 offen offset:2048 nt lds
    s_waitcnt vmcnt(62)
    buffer_load_dwordx4 v7, s[40:43], s78 offen offset:3072 nt lds
    s_waitcnt vmcnt(32)
    s_barrier
    s_add_u32 s78, s77, 65536
    s_mov_b32 m0, 147456
    s_nop 0
    buffer_load_dwordx4 v4, s[40:43], s78 offen nt lds
    buffer_load_dwordx4 v5, s[40:43], s78 offen offset:1024 nt lds
    buffer_load_dwordx4 v6, s[40:43], s78 offen offset:2048 nt lds
    buffer_load_dwordx4 v7, s[40:43], s78 offen offset:3072 nt lds
    s_add_u32 s78, s77, 69632
    s_mov_b32 m0, 151552
    s_nop 0
    buffer_load_dwordx4 v4, s[40:43], s78 offen nt lds
    buffer_load_dwordx4 v5, s[40:43], s78 offen offset:1024 nt lds
    buffer_load_dwordx4 v6, s[40:43], s78 offen offset:2048 nt lds
    buffer_load_dwordx4 v7, s[40:43], s78 offen offset:3072 nt lds
    s_add_u32 s78, s77, 73728
    s_mov_b32 m0, 155648
    s_nop 0
    buffer_load_dwordx4 v4, s[40:43], s78 offen nt lds
    buffer_load_dwordx4 v5, s[40:43], s78 offen offset:1024 nt lds
    buffer_load_dwordx4 v6, s[40:43], s78 offen offset:2048 nt lds
    buffer_load_dwordx4 v7, s[40:43], s78 offen offset:3072 nt lds
    s_add_u32 s78, s77, 77824
    s_mov_b32 m0, 159744
    s_nop 0
    buffer_load_dwordx4 v4, s[40:43], s78 offen nt lds
    buffer_load_dwordx4 v5, s[40:43], s78 offen offset:1024 nt lds
    buffer_load_dwordx4 v6, s[40:43], s78 offen offset:2048 nt lds
    buffer_load_dwordx4 v7, s[40:43], s78 offen offset:3072 nt lds
    s_barrier
    s_barrier
    s_waitcnt vmcnt(32)
    s_barrier
    s_add_u32 s78, s77, 81920
    s_mov_b32 m0, 65536
    s_nop 0
    buffer_load_dwordx4 v4, s[40:43], s78 offen nt lds
    buffer_load_dwordx4 v5, s[40:43], s78 offen offset:1024 nt lds
    buffer_load_dwordx4 v6, s[40:43], s78 offen offset:2048 nt lds
    buffer_load_dwordx4 v7, s[40:43], s78 offen offset:3072 nt lds
    s_add_u32 s78, s77, 86016
    s_mov_b32 m0, 69632
    s_nop 0
    buffer_load_dwordx4 v4, s[40:43], s78 offen nt lds
    buffer_load_dwordx4 v5, s[40:43], s78 offen offset:1024 nt lds
    buffer_load_dwordx4 v6, s[40:43], s78 offen offset:2048 nt lds
    buffer_load_dwordx4 v7, s[40:43], s78 offen offset:3072 nt lds
    s_add_u32 s78, s77, 90112
    s_mov_b32 m0, 73728
    s_nop 0
    buffer_load_dwordx4 v4, s[40:43], s78 offen nt lds
    buffer_load_dwordx4 v5, s[40:43], s78 offen offset:1024 nt lds
    buffer_load_dwordx4 v6, s[40:43], s78 offen offset:2048 nt lds
    buffer_load_dwordx4 v7, s[40:43], s78 offen offset:3072 nt lds
    s_add_u32 s78, s77, 94208
    s_mov_b32 m0, 77824
    s_nop 0
    buffer_load_dwordx4 v4, s[40:43], s78 offen nt lds
    buffer_load_dwordx4 v5, s[40:43], s78 offen offset:1024 nt lds
    buffer_load_dwordx4 v6, s[40:43], s78 offen offset:2048 nt lds
    buffer_load_dwordx4 v7, s[40:43], s78 offen offset:3072 nt lds
    s_waitcnt vmcnt(32)
    s_barrier
    s_add_u32 s78, s77, 98304
    s_mov_b32 m0, 81920
    s_nop 0
    buffer_load_dwordx4 v4, s[40:43], s78 offen nt lds
    buffer_load_dwordx4 v5, s[40:43], s78 offen offset:1024 nt lds
    buffer_load_dwordx4 v6, s[40:43], s78 offen offset:2048 nt lds
    buffer_load_dwordx4 v7, s[40:43], s78 offen offset:3072 nt lds
    s_add_u32 s78, s77, 102400
    s_mov_b32 m0, 86016
    s_nop 0
    buffer_load_dwordx4 v4, s[40:43], s78 offen nt lds
    buffer_load_dwordx4 v5, s[40:43], s78 offen offset:1024 nt lds
    buffer_load_dwordx4 v6, s[40:43], s78 offen offset:2048 nt lds
    buffer_load_dwordx4 v7, s[40:43], s78 offen offset:3072 nt lds
    s_add_u32 s78, s77, 106496
    s_mov_b32 m0, 90112
    s_nop 0
    buffer_load_dwordx4 v4, s[40:43], s78 offen nt lds
    buffer_load_dwordx4 v5, s[40:43], s78 offen offset:1024 nt lds
    buffer_load_dwordx4 v6, s[40:43], s78 offen offset:2048 nt lds
    buffer_load_dwordx4 v7, s[40:43], s78 offen offset:3072 nt lds
    s_add_u32 s78, s77, 110592
    s_mov_b32 m0, 94208
    s_nop 0
    buffer_load_dwordx4 v4, s[40:43], s78 offen nt lds
    buffer_load_dwordx4 v5, s[40:43], s78 offen offset:1024 nt lds
    buffer_load_dwordx4 v6, s[40:43], s78 offen offset:2048 nt lds
    buffer_load_dwordx4 v7, s[40:43], s78 offen offset:3072 nt lds
    s_waitcnt vmcnt(32)
    s_barrier
    s_add_u32 s78, s77, 114688
    s_mov_b32 m0, 98304
    s_nop 0
    buffer_load_dwordx4 v4, s[40:43], s78 offen nt lds
    buffer_load_dwordx4 v5, s[40:43], s78 offen offset:1024 nt lds
    buffer_load_dwordx4 v6, s[40:43], s78 offen offset:2048 nt lds
    buffer_load_dwordx4 v7, s[40:43], s78 offen offset:3072 nt lds
    s_add_u32 s78, s77, 118784
    s_mov_b32 m0, 102400
    s_nop 0
    buffer_load_dwordx4 v4, s[40:43], s78 offen nt lds
    buffer_load_dwordx4 v5, s[40:43], s78 offen offset:1024 nt lds
    buffer_load_dwordx4 v6, s[40:43], s78 offen offset:2048 nt lds
    buffer_load_dwordx4 v7, s[40:43], s78 offen offset:3072 nt lds
    s_add_u32 s78, s77, 122880
    s_mov_b32 m0, 106496
    s_nop 0
    buffer_load_dwordx4 v4, s[40:43], s78 offen nt lds
    buffer_load_dwordx4 v5, s[40:43], s78 offen offset:1024 nt lds
    buffer_load_dwordx4 v6, s[40:43], s78 offen offset:2048 nt lds
    buffer_load_dwordx4 v7, s[40:43], s78 offen offset:3072 nt lds
    s_add_u32 s78, s77, 126976
    s_mov_b32 m0, 110592
    s_nop 0
    buffer_load_dwordx4 v4, s[40:43], s78 offen nt lds
    buffer_load_dwordx4 v5, s[40:43], s78 offen offset:1024 nt lds
    buffer_load_dwordx4 v6, s[40:43], s78 offen offset:2048 nt lds
    buffer_load_dwordx4 v7, s[40:43], s78 offen offset:3072 nt lds
    s_waitcnt vmcnt(32)
    s_barrier
    v_lshrrev_b32 v16, 5, v1
    v_lshlrev_b32 v13, 14, v16
    v_lshrrev_b32 v16, 4, v1
    v_and_b32 v16, 1, v16
    v_lshlrev_b32 v16, 12, v16
    v_add_u32 v13, v13, v16
    v_and_b32 v16, 15, v1
    v_lshlrev_b32 v16, 4, v16
    v_add_u32 v13, v13, v16
    v_add_u32 v14, 0x2000, v13
    s_lshr_b32 s72, s5, 1
    s_add_u32 s73, s72, 14
    s_and_b32 s73, s73, 15
    s_lshl_b32 s73, s73, 15
    s_lshl_b32 s74, s4, 19
    s_or_b32 s73, s73, s74
    s_add_u32 s74, s73, 512
    s_mov_b32 m0, 114688
    s_nop 0
    buffer_load_dwordx4 v13, s[48:51], s74 offen lds
    buffer_load_dwordx4 v13, s[48:51], s74 offen offset:1024 lds
    buffer_load_dwordx4 v13, s[48:51], s74 offen offset:2048 lds
    buffer_load_dwordx4 v13, s[48:51], s74 offen offset:3072 lds
    s_mov_b32 m0, 118784
    s_nop 0
    buffer_load_dwordx4 v14, s[48:51], s74 offen lds
    buffer_load_dwordx4 v14, s[48:51], s74 offen offset:1024 lds
    buffer_load_dwordx4 v14, s[48:51], s74 offen offset:2048 lds
    buffer_load_dwordx4 v14, s[48:51], s74 offen offset:3072 lds
    s_add_u32 s74, s73, 768
    s_mov_b32 m0, 122880
    s_nop 0
    buffer_load_dwordx4 v13, s[48:51], s74 offen lds
    buffer_load_dwordx4 v13, s[48:51], s74 offen offset:1024 lds
    buffer_load_dwordx4 v13, s[48:51], s74 offen offset:2048 lds
    buffer_load_dwordx4 v13, s[48:51], s74 offen offset:3072 lds
    s_mov_b32 m0, 126976
    s_nop 0
    buffer_load_dwordx4 v14, s[48:51], s74 offen lds
    buffer_load_dwordx4 v14, s[48:51], s74 offen offset:1024 lds
    buffer_load_dwordx4 v14, s[48:51], s74 offen offset:2048 lds
    buffer_load_dwordx4 v14, s[48:51], s74 offen offset:3072 lds
    s_waitcnt vmcnt(32)
    s_barrier
    s_add_u32 s73, s72, 15
    s_and_b32 s73, s73, 15
    s_lshl_b32 s73, s73, 15
    s_lshl_b32 s74, s4, 19
    s_or_b32 s73, s73, s74
    s_add_u32 s74, s73, 0
    s_mov_b32 m0, 147456
    s_nop 0
    buffer_load_dwordx4 v13, s[48:51], s74 offen lds
    buffer_load_dwordx4 v13, s[48:51], s74 offen offset:1024 lds
    buffer_load_dwordx4 v13, s[48:51], s74 offen offset:2048 lds
    buffer_load_dwordx4 v13, s[48:51], s74 offen offset:3072 lds
    s_mov_b32 m0, 151552
    s_nop 0
    buffer_load_dwordx4 v14, s[48:51], s74 offen lds
    buffer_load_dwordx4 v14, s[48:51], s74 offen offset:1024 lds
    buffer_load_dwordx4 v14, s[48:51], s74 offen offset:2048 lds
    buffer_load_dwordx4 v14, s[48:51], s74 offen offset:3072 lds
    s_add_u32 s74, s73, 256
    s_mov_b32 m0, 155648
    s_nop 0
    buffer_load_dwordx4 v13, s[48:51], s74 offen lds
    buffer_load_dwordx4 v13, s[48:51], s74 offen offset:1024 lds
    buffer_load_dwordx4 v13, s[48:51], s74 offen offset:2048 lds
    buffer_load_dwordx4 v13, s[48:51], s74 offen offset:3072 lds
    s_mov_b32 m0, 159744
    s_nop 0
    buffer_load_dwordx4 v14, s[48:51], s74 offen lds
    buffer_load_dwordx4 v14, s[48:51], s74 offen offset:1024 lds
    buffer_load_dwordx4 v14, s[48:51], s74 offen offset:2048 lds
    buffer_load_dwordx4 v14, s[48:51], s74 offen offset:3072 lds
    s_waitcnt vmcnt(32)
    s_barrier
    s_add_u32 s73, s72, 15
    s_and_b32 s73, s73, 15
    s_lshl_b32 s73, s73, 15
    s_lshl_b32 s74, s4, 19
    s_or_b32 s73, s73, s74
    s_add_u32 s74, s73, 512
    s_mov_b32 m0, 65536
    s_nop 0
    buffer_load_dwordx4 v13, s[48:51], s74 offen lds
    buffer_load_dwordx4 v13, s[48:51], s74 offen offset:1024 lds
    buffer_load_dwordx4 v13, s[48:51], s74 offen offset:2048 lds
    buffer_load_dwordx4 v13, s[48:51], s74 offen offset:3072 lds
    s_mov_b32 m0, 69632
    s_nop 0
    buffer_load_dwordx4 v14, s[48:51], s74 offen lds
    buffer_load_dwordx4 v14, s[48:51], s74 offen offset:1024 lds
    buffer_load_dwordx4 v14, s[48:51], s74 offen offset:2048 lds
    buffer_load_dwordx4 v14, s[48:51], s74 offen offset:3072 lds
    s_add_u32 s74, s73, 768
    s_mov_b32 m0, 73728
    s_nop 0
    buffer_load_dwordx4 v13, s[48:51], s74 offen lds
    buffer_load_dwordx4 v13, s[48:51], s74 offen offset:1024 lds
    buffer_load_dwordx4 v13, s[48:51], s74 offen offset:2048 lds
    buffer_load_dwordx4 v13, s[48:51], s74 offen offset:3072 lds
    s_mov_b32 m0, 77824
    s_nop 0
    buffer_load_dwordx4 v14, s[48:51], s74 offen lds
    buffer_load_dwordx4 v14, s[48:51], s74 offen offset:1024 lds
    buffer_load_dwordx4 v14, s[48:51], s74 offen offset:2048 lds
    buffer_load_dwordx4 v14, s[48:51], s74 offen offset:3072 lds
    s_barrier
    s_waitcnt vmcnt(0)
    s_barrier
    s_endpgm
L_k1_end:
    s_endpgm
.globl reduce_kernel
.p2align 8
.type reduce_kernel,@function
reduce_kernel:
    s_cmp_ge_u32 s2, 256
    s_cbranch_scc1 L_k2_end
    s_load_dwordx2 s[16:17], s[0:1], 40
    s_load_dwordx2 s[18:19], s[0:1], 56
    v_and_b32 v1, 63, v0
    v_lshrrev_b32 v2, 6, v0
    s_nop 0
    v_readfirstlane_b32 s3, v2
    s_lshr_b32 s5, s2, 3
    s_lshr_b32 s6, s2, 1
    s_and_b32 s6, s6, 3
    s_and_b32 s7, s2, 1
    v_lshlrev_b32 v3, 4, v1
    s_lshl_b32 s8, s5, 18
    s_lshl_b32 s9, s6, 13
    s_add_u32 s8, s8, s9
    s_lshl_b32 s9, s7, 12
    s_add_u32 s8, s8, s9
    s_lshl_b32 s9, s3, 16
    s_add_u32 s8, s8, s9
    s_add_u32 s9, s8, 0x8000
    v_and_b32 v8, 15, v1
    v_lshlrev_b32 v8, 10, v8
    v_lshrrev_b32 v9, 4, v1
    v_lshlrev_b32 v9, 6, v9
    v_add_u32 v8, v8, v9
    s_lshl_b32 s10, s5, 15
    s_lshl_b32 s11, s6, 8
    s_add_u32 s10, s10, s11
    s_lshl_b32 s11, s7, 14
    s_add_u32 s10, s10, s11
    s_lshl_b32 s12, s3, 13
    s_sub_u32 s12, s12, 0x2000
    v_add_u32 v10, s12, v3
    s_mov_b32 s13, 0xffff0000
    s_waitcnt lgkmcnt(0)
    s_mov_b32 s20, s16
    s_and_b32 s21, s17, 0xffff
    s_mov_b32 s22, 0x100000
    s_mov_b32 s23, 0x00020000
    s_mov_b32 s24, s18
    s_and_b32 s25, s19, 0xffff
    s_mov_b32 s26, 0x800000
    s_mov_b32 s27, 0x00020000
    buffer_load_dwordx4 v[64:67], v3, s[24:27], s8 offen
    buffer_load_dwordx4 v[68:71], v3, s[24:27], s8 offen offset:1024
    buffer_load_dwordx4 v[72:75], v3, s[24:27], s8 offen offset:2048
    buffer_load_dwordx4 v[76:79], v3, s[24:27], s8 offen offset:3072
    buffer_load_dwordx4 v[80:83], v3, s[24:27], s9 offen
    buffer_load_dwordx4 v[84:87], v3, s[24:27], s9 offen offset:1024
    buffer_load_dwordx4 v[88:91], v3, s[24:27], s9 offen offset:2048
    buffer_load_dwordx4 v[92:95], v3, s[24:27], s9 offen offset:3072
    s_waitcnt vmcnt(7)
    v_lshlrev_b32 v16, 16, v64
    v_and_b32 v17, s13, v64
    s_waitcnt vmcnt(3)
    v_lshlrev_b32 v64, 16, v80
    v_and_b32 v80, s13, v80
    v_add_f32 v16, v16, v64
    v_add_f32 v17, v17, v80
    v_lshlrev_b32 v18, 16, v65
    v_and_b32 v19, s13, v65
    v_lshlrev_b32 v65, 16, v81
    v_and_b32 v81, s13, v81
    v_add_f32 v18, v18, v65
    v_add_f32 v19, v19, v81
    v_lshlrev_b32 v20, 16, v66
    v_and_b32 v21, s13, v66
    v_lshlrev_b32 v66, 16, v82
    v_and_b32 v82, s13, v82
    v_add_f32 v20, v20, v66
    v_add_f32 v21, v21, v82
    v_lshlrev_b32 v22, 16, v67
    v_and_b32 v23, s13, v67
    v_lshlrev_b32 v67, 16, v83
    v_and_b32 v83, s13, v83
    v_add_f32 v22, v22, v67
    v_add_f32 v23, v23, v83
    v_lshlrev_b32 v24, 16, v68
    v_and_b32 v25, s13, v68
    s_waitcnt vmcnt(2)
    v_lshlrev_b32 v68, 16, v84
    v_and_b32 v84, s13, v84
    v_add_f32 v24, v24, v68
    v_add_f32 v25, v25, v84
    v_lshlrev_b32 v26, 16, v69
    v_and_b32 v27, s13, v69
    v_lshlrev_b32 v69, 16, v85
    v_and_b32 v85, s13, v85
    v_add_f32 v26, v26, v69
    v_add_f32 v27, v27, v85
    v_lshlrev_b32 v28, 16, v70
    v_and_b32 v29, s13, v70
    v_lshlrev_b32 v70, 16, v86
    v_and_b32 v86, s13, v86
    v_add_f32 v28, v28, v70
    v_add_f32 v29, v29, v86
    v_lshlrev_b32 v30, 16, v71
    v_and_b32 v31, s13, v71
    v_lshlrev_b32 v71, 16, v87
    v_and_b32 v87, s13, v87
    v_add_f32 v30, v30, v71
    v_add_f32 v31, v31, v87
    v_lshlrev_b32 v32, 16, v72
    v_and_b32 v33, s13, v72
    s_waitcnt vmcnt(1)
    v_lshlrev_b32 v72, 16, v88
    v_and_b32 v88, s13, v88
    v_add_f32 v32, v32, v72
    v_add_f32 v33, v33, v88
    v_lshlrev_b32 v34, 16, v73
    v_and_b32 v35, s13, v73
    v_lshlrev_b32 v73, 16, v89
    v_and_b32 v89, s13, v89
    v_add_f32 v34, v34, v73
    v_add_f32 v35, v35, v89
    v_lshlrev_b32 v36, 16, v74
    v_and_b32 v37, s13, v74
    v_lshlrev_b32 v74, 16, v90
    v_and_b32 v90, s13, v90
    v_add_f32 v36, v36, v74
    v_add_f32 v37, v37, v90
    v_lshlrev_b32 v38, 16, v75
    v_and_b32 v39, s13, v75
    v_lshlrev_b32 v75, 16, v91
    v_and_b32 v91, s13, v91
    v_add_f32 v38, v38, v75
    v_add_f32 v39, v39, v91
    v_lshlrev_b32 v40, 16, v76
    v_and_b32 v41, s13, v76
    s_waitcnt vmcnt(0)
    v_lshlrev_b32 v76, 16, v92
    v_and_b32 v92, s13, v92
    v_add_f32 v40, v40, v76
    v_add_f32 v41, v41, v92
    v_lshlrev_b32 v42, 16, v77
    v_and_b32 v43, s13, v77
    v_lshlrev_b32 v77, 16, v93
    v_and_b32 v93, s13, v93
    v_add_f32 v42, v42, v77
    v_add_f32 v43, v43, v93
    v_lshlrev_b32 v44, 16, v78
    v_and_b32 v45, s13, v78
    v_lshlrev_b32 v78, 16, v94
    v_and_b32 v94, s13, v94
    v_add_f32 v44, v44, v78
    v_add_f32 v45, v45, v94
    v_lshlrev_b32 v46, 16, v79
    v_and_b32 v47, s13, v79
    v_lshlrev_b32 v79, 16, v95
    v_and_b32 v95, s13, v95
    v_add_f32 v46, v46, v79
    v_add_f32 v47, v47, v95
    s_cmp_eq_u32 s3, 0
    s_cbranch_scc1 L_k2_w0
    ds_write_b128 v10, v[16:19] offset:0
    ds_write_b128 v10, v[20:23] offset:1024
    ds_write_b128 v10, v[24:27] offset:2048
    ds_write_b128 v10, v[28:31] offset:3072
    ds_write_b128 v10, v[32:35] offset:4096
    ds_write_b128 v10, v[36:39] offset:5120
    ds_write_b128 v10, v[40:43] offset:6144
    ds_write_b128 v10, v[44:47] offset:7168
    s_waitcnt lgkmcnt(0)
    s_barrier
    s_endpgm
L_k2_w0:
    s_barrier
    ds_read_b128 v[64:67], v3 offset:0
    ds_read_b128 v[68:71], v3 offset:1024
    ds_read_b128 v[72:75], v3 offset:2048
    ds_read_b128 v[76:79], v3 offset:3072
    ds_read_b128 v[80:83], v3 offset:4096
    ds_read_b128 v[84:87], v3 offset:5120
    ds_read_b128 v[88:91], v3 offset:6144
    ds_read_b128 v[92:95], v3 offset:7168
    ds_read_b128 v[96:99], v3 offset:8192
    ds_read_b128 v[100:103], v3 offset:9216
    ds_read_b128 v[104:107], v3 offset:10240
    ds_read_b128 v[108:111], v3 offset:11264
    ds_read_b128 v[112:115], v3 offset:12288
    ds_read_b128 v[116:119], v3 offset:13312
    ds_read_b128 v[120:123], v3 offset:14336
    s_waitcnt lgkmcnt(14)
    ds_read_b128 v[124:127], v3 offset:15360
    s_waitcnt lgkmcnt(14)
    ds_read_b128 v[128:131], v3 offset:16384
    s_waitcnt lgkmcnt(14)
    ds_read_b128 v[132:135], v3 offset:17408
    s_waitcnt lgkmcnt(14)
    ds_read_b128 v[136:139], v3 offset:18432
    s_waitcnt lgkmcnt(14)
    ds_read_b128 v[140:143], v3 offset:19456
    s_waitcnt lgkmcnt(14)
    ds_read_b128 v[144:147], v3 offset:20480
    s_waitcnt lgkmcnt(14)
    ds_read_b128 v[148:151], v3 offset:21504
    s_waitcnt lgkmcnt(14)
    ds_read_b128 v[152:155], v3 offset:22528
    s_waitcnt lgkmcnt(14)
    ds_read_b128 v[156:159], v3 offset:23552
    v_add_f32 v16, v16, v64
    v_add_f32 v17, v17, v65
    v_add_f32 v18, v18, v66
    v_add_f32 v19, v19, v67
    v_add_f32 v20, v20, v68
    v_add_f32 v21, v21, v69
    v_add_f32 v22, v22, v70
    v_add_f32 v23, v23, v71
    v_add_f32 v24, v24, v72
    v_add_f32 v25, v25, v73
    v_add_f32 v26, v26, v74
    v_add_f32 v27, v27, v75
    v_add_f32 v28, v28, v76
    v_add_f32 v29, v29, v77
    v_add_f32 v30, v30, v78
    v_add_f32 v31, v31, v79
    v_add_f32 v32, v32, v80
    v_add_f32 v33, v33, v81
    v_add_f32 v34, v34, v82
    v_add_f32 v35, v35, v83
    v_add_f32 v36, v36, v84
    v_add_f32 v37, v37, v85
    v_add_f32 v38, v38, v86
    v_add_f32 v39, v39, v87
    v_add_f32 v40, v40, v88
    v_add_f32 v41, v41, v89
    v_add_f32 v42, v42, v90
    v_add_f32 v43, v43, v91
    v_add_f32 v44, v44, v92
    v_add_f32 v45, v45, v93
    v_add_f32 v46, v46, v94
    v_add_f32 v47, v47, v95
    v_add_f32 v16, v16, v96
    v_add_f32 v17, v17, v97
    v_add_f32 v18, v18, v98
    v_add_f32 v19, v19, v99
    s_waitcnt lgkmcnt(14)
    v_add_f32 v20, v20, v100
    v_add_f32 v21, v21, v101
    v_add_f32 v22, v22, v102
    v_add_f32 v23, v23, v103
    s_waitcnt lgkmcnt(13)
    v_add_f32 v24, v24, v104
    v_add_f32 v25, v25, v105
    v_add_f32 v26, v26, v106
    v_add_f32 v27, v27, v107
    s_waitcnt lgkmcnt(12)
    v_add_f32 v28, v28, v108
    v_add_f32 v29, v29, v109
    v_add_f32 v30, v30, v110
    v_add_f32 v31, v31, v111
    s_waitcnt lgkmcnt(11)
    v_add_f32 v32, v32, v112
    v_add_f32 v33, v33, v113
    v_add_f32 v34, v34, v114
    v_add_f32 v35, v35, v115
    s_waitcnt lgkmcnt(10)
    v_add_f32 v36, v36, v116
    v_add_f32 v37, v37, v117
    v_add_f32 v38, v38, v118
    v_add_f32 v39, v39, v119
    s_waitcnt lgkmcnt(9)
    v_add_f32 v40, v40, v120
    v_add_f32 v41, v41, v121
    v_add_f32 v42, v42, v122
    v_add_f32 v43, v43, v123
    s_waitcnt lgkmcnt(8)
    v_add_f32 v44, v44, v124
    v_add_f32 v45, v45, v125
    v_add_f32 v46, v46, v126
    v_add_f32 v47, v47, v127
    s_waitcnt lgkmcnt(7)
    v_add_f32 v16, v16, v128
    v_add_f32 v17, v17, v129
    v_add_f32 v18, v18, v130
    v_add_f32 v19, v19, v131
    s_waitcnt lgkmcnt(6)
    v_add_f32 v20, v20, v132
    v_add_f32 v21, v21, v133
    v_add_f32 v22, v22, v134
    v_add_f32 v23, v23, v135
    s_waitcnt lgkmcnt(5)
    v_add_f32 v24, v24, v136
    v_add_f32 v25, v25, v137
    v_add_f32 v26, v26, v138
    v_add_f32 v27, v27, v139
    s_waitcnt lgkmcnt(4)
    v_add_f32 v28, v28, v140
    v_add_f32 v29, v29, v141
    v_add_f32 v30, v30, v142
    v_add_f32 v31, v31, v143
    s_waitcnt lgkmcnt(3)
    v_add_f32 v32, v32, v144
    v_add_f32 v33, v33, v145
    v_add_f32 v34, v34, v146
    v_add_f32 v35, v35, v147
    s_waitcnt lgkmcnt(2)
    v_add_f32 v36, v36, v148
    v_add_f32 v37, v37, v149
    v_add_f32 v38, v38, v150
    v_add_f32 v39, v39, v151
    s_waitcnt lgkmcnt(1)
    v_add_f32 v40, v40, v152
    v_add_f32 v41, v41, v153
    v_add_f32 v42, v42, v154
    v_add_f32 v43, v43, v155
    s_waitcnt lgkmcnt(0)
    v_add_f32 v44, v44, v156
    v_add_f32 v45, v45, v157
    v_add_f32 v46, v46, v158
    v_add_f32 v47, v47, v159
    v_cvt_pk_bf16_f32 v160, v16, v17
    v_cvt_pk_bf16_f32 v161, v18, v19
    v_cvt_pk_bf16_f32 v162, v20, v21
    v_cvt_pk_bf16_f32 v163, v22, v23
    v_cvt_pk_bf16_f32 v164, v24, v25
    v_cvt_pk_bf16_f32 v165, v26, v27
    v_cvt_pk_bf16_f32 v166, v28, v29
    v_cvt_pk_bf16_f32 v167, v30, v31
    v_cvt_pk_bf16_f32 v168, v32, v33
    v_cvt_pk_bf16_f32 v169, v34, v35
    v_cvt_pk_bf16_f32 v170, v36, v37
    v_cvt_pk_bf16_f32 v171, v38, v39
    v_cvt_pk_bf16_f32 v172, v40, v41
    v_cvt_pk_bf16_f32 v173, v42, v43
    v_cvt_pk_bf16_f32 v174, v44, v45
    v_cvt_pk_bf16_f32 v175, v46, v47
    buffer_store_dwordx4 v[160:163], v8, s[20:23], s10 offen
    buffer_store_dwordx4 v[164:167], v8, s[20:23], s10 offen offset:16
    buffer_store_dwordx4 v[168:171], v8, s[20:23], s10 offen offset:32
    buffer_store_dwordx4 v[172:175], v8, s[20:23], s10 offen offset:48
L_k2_end:
    s_endpgm
.section .rodata,"a"
.p2align 6
.amdhsa_kernel standalone__gqa_block_cached__near_ridge_kernel
  .amdhsa_next_free_vgpr 256
  .amdhsa_next_free_sgpr 102
  .amdhsa_accum_offset 256
  .amdhsa_group_segment_fixed_size 0
  .amdhsa_kernarg_size 64
  .amdhsa_user_sgpr_count 2
  .amdhsa_user_sgpr_kernarg_segment_ptr 1
  .amdhsa_system_sgpr_workgroup_id_x 1
.end_amdhsa_kernel
.p2align 6
.amdhsa_kernel reduce_kernel
  .amdhsa_next_free_vgpr 192
  .amdhsa_next_free_sgpr 102
  .amdhsa_accum_offset 192
  .amdhsa_group_segment_fixed_size 0
  .amdhsa_kernarg_size 64
  .amdhsa_user_sgpr_count 2
  .amdhsa_user_sgpr_kernarg_segment_ptr 1
  .amdhsa_system_sgpr_workgroup_id_x 1
.end_amdhsa_kernel
```
